```python
import torch

def _softmax(x, axis=-1):
    return torch.softmax(x, dim=axis)
def _gelu(x):
    return torch.nn.functional.gelu(x, approximate="tanh")
def _silu(x):
    return torch.nn.functional.silu(x)
def _sigmoid(x):
    return torch.sigmoid(x)
def _layernorm(x, axis=-1, eps=1e-5):
    m = x.mean(dim=axis, keepdim=True)
    v = x.var(dim=axis, keepdim=True, unbiased=False)
    return (x - m) / torch.sqrt(v + eps)
def _scatter_add(tgt, idx, src, axis=0):
    return tgt.clone().index_add_(axis, idx, src)
def _segment_sum(src, seg, n):
    out = torch.zeros((n,) + src.shape[1:], dtype=src.dtype)
    return out.index_add_(0, seg, src)
def _pad(x, pw):
    flat = tuple(v for pair in reversed(pw) for v in pair)
    return torch.nn.functional.pad(x, flat)

kernel_name = 'interleave_layers__mha_block__glu_gated_bilinear__prompt'

def setup_inputs():

    _w = (lambda a: (lambda t: t.to(torch.bfloat16) if t.is_floating_point() else t)(torch.as_tensor(a)))
    def _A_setup():
        B, S, D, H = 1, 2048, 512, 32
        return {
            "x": _w((lambda *s: torch.randn(*s, dtype=torch.bfloat16) * 0.05)(B, S, D)),
            "wqkv": _w((lambda *s: torch.randn(*s, dtype=torch.bfloat16) * 0.05)(D, 3 * D)),
            "wo": _w((lambda *s: torch.randn(*s, dtype=torch.bfloat16) * 0.05)(D, D)),
        }
    _A_in = _A_setup()

    def _B_setup():
        B, S, D, F = 1, 2048, 512, 1792
        return {
            "x": _w((lambda *s: torch.randn(*s, dtype=torch.bfloat16) * 0.05)(B, S, D)),
            "w_gate": _w((lambda *s: torch.randn(*s, dtype=torch.bfloat16) * 0.4)(D, F) * (D ** -0.5)),
            "w_up": _w((lambda *s: torch.randn(*s, dtype=torch.bfloat16) * 0.4)(D, F) * (D ** -0.5)),
            "w_down": _w((lambda *s: torch.randn(*s, dtype=torch.bfloat16) * 0.4)(F, D) * (F ** -0.5)),
        }
    _B_in = _B_setup()

    return {
        "A_x": _A_in["x"],
        "A_wqkv": _A_in["wqkv"],
        "A_wo": _A_in["wo"],
        "B_x": _B_in["x"],
        "B_w_gate": _B_in["w_gate"],
        "B_w_up": _B_in["w_up"],
        "B_w_down": _B_in["w_down"],
    }

def reference(A_x, A_wqkv, A_wo, B_x, B_w_gate, B_w_up, B_w_down):
    def _A_ref(x, wqkv, wo):
        B, S, D = x.shape
        H = 32
        Dh = D // H
        qkv = (lambda x, *d: x.permute(*d))((x @ wqkv).reshape(B, S, 3, H, Dh), 2, 0, 3, 1, 4)
        q, k, v = qkv[0], qkv[1], qkv[2]
        scores = torch.einsum("bhqd,bhkd->bhqk", q, k) * (Dh ** -0.5)
        p = _softmax(scores, axis=-1)
        o = torch.einsum("bhqk,bhkd->bhqd", p, v)
        return (lambda x, *d: x.permute(*d))(o, 0, 2, 1, 3).reshape(B, S, D) @ wo

    def _B_ref(x, w_gate, w_up, w_down):
        g = torch.einsum("bsd,df->bsf", x, w_gate)
        u = torch.einsum("bsd,df->bsf", x, w_up)
        h = g * u
        return torch.einsum("bsf,fd->bsd", h, w_down)

    x = A_x
    x = x + _A_ref(_layernorm(x, axis=-1), A_wqkv, A_wo)
    x = x + _B_ref(_layernorm(x, axis=-1), B_w_gate, B_w_up, B_w_down)
    x = x + _A_ref(_layernorm(x, axis=-1), A_wqkv, A_wo)
    x = x + _B_ref(_layernorm(x, axis=-1), B_w_gate, B_w_up, B_w_down)
    return x
```

```asm
; @launch grid=(256,1,1) block=(512,1,1) lds=163840
.amdgcn_target "amdgcn-amd-amdhsa--gfx950"
.text
.globl interleave_layers__mha_block__glu_gated_bilinear__prompt_kernel
.p2align 8
.type interleave_layers__mha_block__glu_gated_bilinear__prompt_kernel,@function
interleave_layers__mha_block__glu_gated_bilinear__prompt_kernel:
    s_cmp_ge_u32 s2, 256
    s_cbranch_scc1 L_done_1
    s_load_dwordx4 s[64:67], s[0:1], 0
    s_getpc_b64 s[98:99]
    v_lshlrev_b32 v16, 5, v0
    global_load_dword v14, v16, s[98:99]
    s_and_b32 s17, s2, 7
    s_bfe_u32 s19, s2, 0x30003
    s_lshr_b32 s24, s17, 1
    s_lshl3_add_u32 s19, s24, s19
    v_lshrrev_b32 v1, 6, v0
    v_and_b32 v0, 63, v0
    v_lshlrev_b32 v2, 4, v0
    s_mov_b32 s32, 0
    v_lshl_add_u32 v16, s19, 3, v1
    v_lshl_add_u32 v16, v16, 13, v2
    s_waitcnt lgkmcnt(0)
    s_add_u32 s20, s64, 4096
    s_addc_u32 s21, s65, 0
    global_load_dwordx4 v[20:23], v16, s[20:21] offset:-4096
    global_load_dwordx4 v[24:27], v16, s[20:21] offset:-3072
    global_load_dwordx4 v[28:31], v16, s[20:21] offset:-2048
    global_load_dwordx4 v[32:35], v16, s[20:21] offset:-1024
    global_load_dwordx4 v[36:39], v16, s[20:21] offset:0
    global_load_dwordx4 v[40:43], v16, s[20:21] offset:1024
    global_load_dwordx4 v[44:47], v16, s[20:21] offset:2048
    global_load_dwordx4 v[48:51], v16, s[20:21] offset:3072
    s_load_dwordx2 s[68:69], s[0:1], 16
    s_load_dwordx4 s[72:75], s[0:1], 32
    s_load_dwordx2 s[76:77], s[0:1], 48
    s_load_dwordx2 s[70:71], s[0:1], 56
    s_load_dwordx2 s[94:95], s[0:1], 64
    s_load_dwordx2 s[12:13], s[0:1], 72
    v_readfirstlane_b32 s16, v1
    v_lshlrev_b32 v15, 7, v0
    s_lshr_b32 s18, s2, 3
    s_mov_b32 s20, s66
    s_and_b32 s21, s67, 0xffff
    s_mov_b32 s22, 0x180000
    s_mov_b32 s23, 0x20000
    s_lshl3_add_u32 s31, s18, s16
    s_mul_i32 s31, s31, 6144
    s_and_b32 s26, s17, 1
    s_mul_i32 s26, s26, 512
    s_add_u32 s31, s31, s26
    v_lshrrev_b32 v4, 2, v0
    v_and_b32 v5, 3, v0
    v_lshlrev_b32 v4, 10, v4
    v_lshl_add_u32 v4, v5, 7, v4
    s_lshl_b32 s43, s19, 1
    s_and_b32 s26, s17, 1
    s_mul_i32 s26, s26, 4
    s_lshr_b32 s44, s18, 3
    s_add_u32 s44, s44, s26
    s_and_b32 s45, s18, 3
    s_lshr_b32 s19, s17, 1
    s_lshl_b32 s19, s19, 2
    s_add_u32 s45, s45, s19
    s_lshl_b32 s45, s45, 2
    s_lshr_b32 s46, s18, 2
    s_and_b32 s19, s17, 1
    s_mul_i32 s19, s19, 8
    s_add_u32 s46, s46, s19
    s_mov_b32 s40, 0
    s_mov_b32 s41, 0xa00000
    s_mov_b32 s42, 0
    s_mov_b32 s48, 0
    v_and_b32 v3, 15, v0
    v_lshlrev_b32 v3, 4, v3
    v_lshrrev_b32 v1, 4, v0
    v_lshl_add_u32 v3, v1, 2, v3
    v_lshlrev_b32 v1, 2, v0
    v_lshrrev_b32 v17, 3, v0
    v_bfe_u32 v18, v0, 4, 1
    v_lshlrev_b32 v18, 1, v18
    s_and_b32 s54, s16, 1
    s_lshl_b32 s54, s54, 2
    v_and_b32 v84, 7, v0
    v_xor_b32 v84, v84, v18
    v_xor_b32 v84, s54, v84
    v_lshlrev_b32 v84, 4, v84
    v_mul_u32_u24 v16, 3072, v17
    v_add_u32 v16, v16, v84
    s_and_b32 s50, s16, 3
    s_waitcnt lgkmcnt(0)
    s_mov_b32 s8, s64
    s_and_b32 s9, s65, 0xffff
    s_mov_b32 s10, 0x200000
    s_mov_b32 s11, 0x20000
    s_mov_b32 s4, s12
    s_and_b32 s5, s13, 0xffff
    s_mov_b32 s6, 0x3200000
    s_mov_b32 s7, 0x20000
    s_sub_u32 s47, 7, s16
    s_lshl_b32 s47, s47, 8
    s_add_u32 s47, s47, s2
    s_cmp_ge_u32 s47, 6
    s_cbranch_scc1 L_nozero_4
    v_lshlrev_b32 v52, 8, v0
    v_mov_b32 v56, 0
    v_mov_b32 v57, 0
    v_mov_b32 v58, 0
    v_mov_b32 v59, 0
    s_lshl_b32 s54, s2, 14
    s_add_u32 s54, s54, 0x8c0000
    buffer_store_dwordx4 v[56:59], v52, s[4:7], s54 offen sc1
L_nozero_4:
    s_add_u32 s14, s12, 0x8c0000
    s_addc_u32 s15, s13, 0
    s_mov_b32 s49, 0x3f803f80
    s_lshr_b32 s55, s16, 2
    s_xor_b32 s39, s32, s16
    s_lshr_b32 s39, s39, 2
    s_mul_i32 s39, s39, 33280
    s_lshl_b32 s54, s50, 7
    s_add_u32 s39, s39, s54
    v_lshrrev_b32 v19, 1, v0
    v_lshlrev_b32 v19, 4, v19
    v_lshl_add_u32 v19, v0, 9, v19
    v_add_u32 v19, s39, v19
    s_mul_i32 s62, s50, 24576
    s_lshl_b32 s54, s44, 7
    s_add_u32 s62, s62, s54
    s_mul_i32 s54, s55, 196608
    s_add_u32 s62, s62, s54
    s_lshl_b32 s63, s50, 10
    s_add_u32 s63, s63, 66560
    s_mul_i32 s54, s55, 24576
    s_add_u32 s48, s63, s54
    s_and_b32 s24, s16, 1
    s_bfe_u32 s25, s16, 0x10001
    s_mul_i32 s26, s24, 33280
    v_lshrrev_b32 v87, 4, v0
    v_lshrrev_b32 v86, 5, v0
    v_lshlrev_b32 v86, 4, v86
    v_lshl_add_u32 v86, v87, 9, v86
    v_and_b32 v204, 15, v0
    v_lshl_add_u32 v86, v204, 4, v86
    v_add_u32 v86, s26, v86
    v_bfe_u32 v205, v0, 2, 2
    v_lshl_add_u32 v88, v87, 3, v205
    v_lshlrev_b32 v88, 7, v88
    v_and_b32 v205, 1, v0
    v_bfe_u32 v206, v0, 1, 1
    v_lshl_add_u32 v205, v205, 1, v206
    v_lshl_add_u32 v88, v205, 3, v88
    v_bfe_u32 v205, v0, 3, 2
    s_lshl_b32 s26, s25, 1
    v_xor_b32 v205, s26, v205
    v_lshl_add_u32 v88, v205, 5, v88
    v_add_u32 v88, 66560, v88
    v_xor_b32 v90, 32, v88
    v_add_u32 v89, 0x10000, v88
    v_add_u32 v91, 0x10000, v90
    v_lshlrev_b32 v207, 9, v87
    v_lshl_add_u32 v207, v204, 4, v207
    v_and_b32 v87, 0x3ff, v207
    v_lshrrev_b32 v205, 5, v0
    v_lshl_add_u32 v87, v205, 8, v87
    s_lshl_b32 s30, s44, 1
    s_add_u32 s30, s30, s25
    s_lshl_b32 s30, s30, 17
    s_add_u32 s27, s43, s24
    s_lshl_b32 s27, s27, 10
    s_add_u32 s30, s30, s27
    s_mov_b32 s28, 0x3eb8aa3b
    s_mov_b32 s29, s28
    s_waitcnt vmcnt(7)
    s_mov_b32 exec_lo, 0xffffff
    s_mov_b32 exec_hi, 0x0
    buffer_load_dword v14, v4, s[20:23], s31 offen
    s_mov_b64 exec, -1
    v_dot2_f32_bf16 v52, v20, s49, 0
    v_dot2_f32_bf16 v60, v20, v20, 0
    v_dot2_f32_bf16 v52, v21, s49, v52
    v_dot2_f32_bf16 v60, v21, v21, v60
    v_dot2_f32_bf16 v52, v22, s49, v52
    v_dot2_f32_bf16 v60, v22, v22, v60
    v_dot2_f32_bf16 v52, v23, s49, v52
    v_dot2_f32_bf16 v60, v23, v23, v60
    s_waitcnt vmcnt(7)
    v_dot2_f32_bf16 v53, v24, s49, 0
    v_dot2_f32_bf16 v61, v24, v24, 0
    v_dot2_f32_bf16 v53, v25, s49, v53
    v_dot2_f32_bf16 v61, v25, v25, v61
    v_dot2_f32_bf16 v53, v26, s49, v53
    v_dot2_f32_bf16 v61, v26, v26, v61
    v_dot2_f32_bf16 v53, v27, s49, v53
    v_dot2_f32_bf16 v61, v27, v27, v61
    s_waitcnt vmcnt(6)
    v_dot2_f32_bf16 v54, v28, s49, 0
    v_dot2_f32_bf16 v62, v28, v28, 0
    v_dot2_f32_bf16 v54, v29, s49, v54
    v_dot2_f32_bf16 v62, v29, v29, v62
    v_dot2_f32_bf16 v54, v30, s49, v54
    v_dot2_f32_bf16 v62, v30, v30, v62
    v_dot2_f32_bf16 v54, v31, s49, v54
    v_dot2_f32_bf16 v62, v31, v31, v62
    s_waitcnt vmcnt(5)
    v_dot2_f32_bf16 v55, v32, s49, 0
    v_dot2_f32_bf16 v63, v32, v32, 0
    v_dot2_f32_bf16 v55, v33, s49, v55
    v_dot2_f32_bf16 v63, v33, v33, v63
    v_dot2_f32_bf16 v55, v34, s49, v55
    v_dot2_f32_bf16 v63, v34, v34, v63
    v_dot2_f32_bf16 v55, v35, s49, v55
    v_dot2_f32_bf16 v63, v35, v35, v63
    s_waitcnt vmcnt(4)
    v_dot2_f32_bf16 v56, v36, s49, 0
    v_dot2_f32_bf16 v64, v36, v36, 0
    v_dot2_f32_bf16 v56, v37, s49, v56
    s_add_u32 s54, s48, 0
    s_mov_b32 m0, s54
    s_nop 0
    buffer_load_dwordx4 v16, s[20:23], s62 offen offset:0 lds
    v_dot2_f32_bf16 v64, v37, v37, v64
    v_dot2_f32_bf16 v56, v38, s49, v56
    v_dot2_f32_bf16 v64, v38, v38, v64
    v_dot2_f32_bf16 v56, v39, s49, v56
    v_dot2_f32_bf16 v64, v39, v39, v64
    s_waitcnt vmcnt(4)
    v_dot2_f32_bf16 v57, v40, s49, 0
    v_dot2_f32_bf16 v65, v40, v40, 0
    v_dot2_f32_bf16 v57, v41, s49, v57
    v_dot2_f32_bf16 v65, v41, v41, v65
    v_dot2_f32_bf16 v57, v42, s49, v57
    v_dot2_f32_bf16 v65, v42, v42, v65
    v_dot2_f32_bf16 v57, v43, s49, v57
    v_dot2_f32_bf16 v65, v43, v43, v65
    s_waitcnt vmcnt(3)
    v_dot2_f32_bf16 v58, v44, s49, 0
    v_dot2_f32_bf16 v66, v44, v44, 0
    v_dot2_f32_bf16 v58, v45, s49, v58
    v_dot2_f32_bf16 v66, v45, v45, v66
    v_dot2_f32_bf16 v58, v46, s49, v58
    v_dot2_f32_bf16 v66, v46, v46, v66
    v_dot2_f32_bf16 v58, v47, s49, v58
    v_dot2_f32_bf16 v66, v47, v47, v66
    s_waitcnt vmcnt(2)
    v_dot2_f32_bf16 v59, v48, s49, 0
    v_dot2_f32_bf16 v67, v48, v48, 0
    v_dot2_f32_bf16 v59, v49, s49, v59
    v_dot2_f32_bf16 v67, v49, v49, v67
    v_dot2_f32_bf16 v59, v50, s49, v59
    v_dot2_f32_bf16 v67, v50, v50, v67
    s_add_u32 s54, s48, 3072
    s_mov_b32 m0, s54
    s_nop 0
    buffer_load_dwordx4 v16, s[20:23], s62 offen offset:1024 lds
    v_dot2_f32_bf16 v59, v51, s49, v59
    v_dot2_f32_bf16 v67, v51, v51, v67
    s_nop 2
    v_permlane32_swap_b32 v52, v56
    v_permlane32_swap_b32 v53, v57
    v_permlane32_swap_b32 v54, v58
    v_permlane32_swap_b32 v55, v59
    v_permlane32_swap_b32 v60, v64
    v_permlane32_swap_b32 v61, v65
    v_permlane32_swap_b32 v62, v66
    v_permlane32_swap_b32 v63, v67
    v_add_f32 v52, v52, v56
    v_add_f32 v53, v53, v57
    v_add_f32 v54, v54, v58
    v_add_f32 v55, v55, v59
    v_add_f32 v60, v60, v64
    v_add_f32 v61, v61, v65
    v_add_f32 v62, v62, v66
    v_add_f32 v63, v63, v67
    s_nop 1
    v_permlane16_swap_b32 v52, v54
    v_permlane16_swap_b32 v53, v55
    v_permlane16_swap_b32 v60, v62
    v_permlane16_swap_b32 v61, v63
    v_add_f32 v52, v52, v54
    v_add_f32 v53, v53, v55
    v_add_f32 v60, v60, v62
    v_add_f32 v61, v61, v63
    v_add_f32_dpp v52, v52, v52 row_ror:8 row_mask:0xf bank_mask:0xf
    v_add_f32_dpp v53, v53, v53 row_ror:8 row_mask:0xf bank_mask:0xf
    s_add_u32 s54, s48, 6144
    s_mov_b32 m0, s54
    s_nop 0
    buffer_load_dwordx4 v16, s[20:23], s62 offen offset:2048 lds
    s_add_u32 s62, s62, 98304
    v_add_f32_dpp v60, v60, v60 row_ror:8 row_mask:0xf bank_mask:0xf
    v_add_f32_dpp v61, v61, v61 row_ror:8 row_mask:0xf bank_mask:0xf
    v_add_f32_dpp v52, v52, v52 row_ror:4 row_mask:0xf bank_mask:0xf
    v_add_f32_dpp v53, v53, v53 row_ror:4 row_mask:0xf bank_mask:0xf
    v_add_f32_dpp v60, v60, v60 row_ror:4 row_mask:0xf bank_mask:0xf
    v_add_f32_dpp v61, v61, v61 row_ror:4 row_mask:0xf bank_mask:0xf
    v_add_f32_dpp v52, v52, v52 quad_perm:[2,3,0,1] row_mask:0xf bank_mask:0xf
    v_add_f32_dpp v53, v53, v53 quad_perm:[2,3,0,1] row_mask:0xf bank_mask:0xf
    v_add_f32_dpp v60, v60, v60 quad_perm:[2,3,0,1] row_mask:0xf bank_mask:0xf
    v_add_f32_dpp v61, v61, v61 quad_perm:[2,3,0,1] row_mask:0xf bank_mask:0xf
    v_add_f32_dpp v52, v52, v52 quad_perm:[1,0,3,2] row_mask:0xf bank_mask:0xf
    v_add_f32_dpp v53, v53, v53 quad_perm:[1,0,3,2] row_mask:0xf bank_mask:0xf
    v_add_f32_dpp v60, v60, v60 quad_perm:[1,0,3,2] row_mask:0xf bank_mask:0xf
    v_add_f32_dpp v61, v61, v61 quad_perm:[1,0,3,2] row_mask:0xf bank_mask:0xf
    v_mul_f32 v52, 0xbb000000, v52
    v_mul_f32 v60, 0x3b000000, v60
    v_mul_f32 v53, 0xbb000000, v53
    v_mul_f32 v61, 0x3b000000, v61
    v_fma_f32 v60, -v52, v52, v60
    v_fma_f32 v61, -v53, v53, v61
    v_max_f32 v60, 0, v60
    v_max_f32 v61, 0, v61
    v_add_f32 v60, 0x3727c5ac, v60
    v_add_f32 v61, 0x3727c5ac, v61
    v_rsq_f32 v60, v60
    v_rsq_f32 v61, v61
    s_nop 0
    v_mul_f32 v52, v52, v60
    v_mul_f32 v53, v53, v61
    s_nop 0
    s_add_u32 s54, s48, 12288
    s_mov_b32 m0, s54
    s_nop 0
    buffer_load_dwordx4 v16, s[20:23], s62 offen offset:0 lds
    v_readlane_b32 s78, v60, 0
    v_readlane_b32 s79, v52, 0
    v_readlane_b32 s80, v61, 0
    v_readlane_b32 s81, v53, 0
    v_readlane_b32 s82, v60, 16
    v_readlane_b32 s83, v52, 16
    v_readlane_b32 s84, v61, 16
    v_readlane_b32 s85, v53, 16
    v_readlane_b32 s86, v60, 32
    v_readlane_b32 s87, v52, 32
    v_readlane_b32 s88, v61, 32
    v_readlane_b32 s89, v53, 32
    v_readlane_b32 s90, v60, 48
    v_readlane_b32 s91, v52, 48
    v_readlane_b32 s92, v61, 48
    v_readlane_b32 s93, v53, 48
    v_lshlrev_b32 v68, 16, v20
    v_and_b32 v69, 0xffff0000, v20
    v_lshlrev_b32 v70, 16, v21
    v_and_b32 v71, 0xffff0000, v21
    v_lshlrev_b32 v72, 16, v22
    v_and_b32 v73, 0xffff0000, v22
    v_lshlrev_b32 v74, 16, v23
    v_and_b32 v75, 0xffff0000, v23
    v_pk_fma_f32 v[68:69], v[68:69], s[78:79], s[78:79] op_sel:[0,0,1] op_sel_hi:[1,0,1]
    v_pk_fma_f32 v[70:71], v[70:71], s[78:79], s[78:79] op_sel:[0,0,1] op_sel_hi:[1,0,1]
    v_pk_fma_f32 v[72:73], v[72:73], s[78:79], s[78:79] op_sel:[0,0,1] op_sel_hi:[1,0,1]
    v_pk_fma_f32 v[74:75], v[74:75], s[78:79], s[78:79] op_sel:[0,0,1] op_sel_hi:[1,0,1]
    v_cvt_pk_bf16_f32 v20, v68, v69
    v_cvt_pk_bf16_f32 v21, v70, v71
    s_add_u32 s54, s48, 15360
    s_mov_b32 m0, s54
    s_nop 0
    buffer_load_dwordx4 v16, s[20:23], s62 offen offset:1024 lds
    v_cvt_pk_bf16_f32 v22, v72, v73
    v_cvt_pk_bf16_f32 v23, v74, v75
    ds_write_b128 v19, v[20:23] offset:0
    v_lshlrev_b32 v76, 16, v24
    v_and_b32 v77, 0xffff0000, v24
    v_lshlrev_b32 v78, 16, v25
    v_and_b32 v79, 0xffff0000, v25
    v_lshlrev_b32 v80, 16, v26
    v_and_b32 v81, 0xffff0000, v26
    v_lshlrev_b32 v82, 16, v27
    v_and_b32 v83, 0xffff0000, v27
    v_pk_fma_f32 v[76:77], v[76:77], s[80:81], s[80:81] op_sel:[0,0,1] op_sel_hi:[1,0,1]
    v_pk_fma_f32 v[78:79], v[78:79], s[80:81], s[80:81] op_sel:[0,0,1] op_sel_hi:[1,0,1]
    v_pk_fma_f32 v[80:81], v[80:81], s[80:81], s[80:81] op_sel:[0,0,1] op_sel_hi:[1,0,1]
    v_pk_fma_f32 v[82:83], v[82:83], s[80:81], s[80:81] op_sel:[0,0,1] op_sel_hi:[1,0,1]
    v_cvt_pk_bf16_f32 v24, v76, v77
    v_cvt_pk_bf16_f32 v25, v78, v79
    v_cvt_pk_bf16_f32 v26, v80, v81
    v_cvt_pk_bf16_f32 v27, v82, v83
    ds_write_b128 v19, v[24:27] offset:16
    v_lshlrev_b32 v68, 16, v28
    v_and_b32 v69, 0xffff0000, v28
    v_lshlrev_b32 v70, 16, v29
    v_and_b32 v71, 0xffff0000, v29
    v_lshlrev_b32 v72, 16, v30
    v_and_b32 v73, 0xffff0000, v30
    v_lshlrev_b32 v74, 16, v31
    v_and_b32 v75, 0xffff0000, v31
    v_pk_fma_f32 v[68:69], v[68:69], s[82:83], s[82:83] op_sel:[0,0,1] op_sel_hi:[1,0,1]
    v_pk_fma_f32 v[70:71], v[70:71], s[82:83], s[82:83] op_sel:[0,0,1] op_sel_hi:[1,0,1]
    s_add_u32 s54, s48, 18432
    s_mov_b32 m0, s54
    s_nop 0
    buffer_load_dwordx4 v16, s[20:23], s62 offen offset:2048 lds
    s_add_u32 s62, s62, 98304
    v_pk_fma_f32 v[72:73], v[72:73], s[82:83], s[82:83] op_sel:[0,0,1] op_sel_hi:[1,0,1]
    v_pk_fma_f32 v[74:75], v[74:75], s[82:83], s[82:83] op_sel:[0,0,1] op_sel_hi:[1,0,1]
    v_cvt_pk_bf16_f32 v28, v68, v69
    v_cvt_pk_bf16_f32 v29, v70, v71
    v_cvt_pk_bf16_f32 v30, v72, v73
    v_cvt_pk_bf16_f32 v31, v74, v75
    ds_write_b128 v19, v[28:31] offset:32
    v_lshlrev_b32 v76, 16, v32
    v_and_b32 v77, 0xffff0000, v32
    v_lshlrev_b32 v78, 16, v33
    v_and_b32 v79, 0xffff0000, v33
    v_lshlrev_b32 v80, 16, v34
    v_and_b32 v81, 0xffff0000, v34
    v_lshlrev_b32 v82, 16, v35
    v_and_b32 v83, 0xffff0000, v35
    v_pk_fma_f32 v[76:77], v[76:77], s[84:85], s[84:85] op_sel:[0,0,1] op_sel_hi:[1,0,1]
    v_pk_fma_f32 v[78:79], v[78:79], s[84:85], s[84:85] op_sel:[0,0,1] op_sel_hi:[1,0,1]
    v_pk_fma_f32 v[80:81], v[80:81], s[84:85], s[84:85] op_sel:[0,0,1] op_sel_hi:[1,0,1]
    v_pk_fma_f32 v[82:83], v[82:83], s[84:85], s[84:85] op_sel:[0,0,1] op_sel_hi:[1,0,1]
    v_cvt_pk_bf16_f32 v32, v76, v77
    v_cvt_pk_bf16_f32 v33, v78, v79
    v_cvt_pk_bf16_f32 v34, v80, v81
    v_cvt_pk_bf16_f32 v35, v82, v83
    ds_write_b128 v19, v[32:35] offset:48
    v_lshlrev_b32 v68, 16, v36
    v_and_b32 v69, 0xffff0000, v36
    v_lshlrev_b32 v70, 16, v37
    v_and_b32 v71, 0xffff0000, v37
    v_lshlrev_b32 v72, 16, v38
    v_and_b32 v73, 0xffff0000, v38
    v_lshlrev_b32 v74, 16, v39
    v_and_b32 v75, 0xffff0000, v39
    v_pk_fma_f32 v[68:69], v[68:69], s[86:87], s[86:87] op_sel:[0,0,1] op_sel_hi:[1,0,1]
    v_pk_fma_f32 v[70:71], v[70:71], s[86:87], s[86:87] op_sel:[0,0,1] op_sel_hi:[1,0,1]
    v_pk_fma_f32 v[72:73], v[72:73], s[86:87], s[86:87] op_sel:[0,0,1] op_sel_hi:[1,0,1]
    v_pk_fma_f32 v[74:75], v[74:75], s[86:87], s[86:87] op_sel:[0,0,1] op_sel_hi:[1,0,1]
    v_cvt_pk_bf16_f32 v36, v68, v69
    v_cvt_pk_bf16_f32 v37, v70, v71
    v_cvt_pk_bf16_f32 v38, v72, v73
    v_cvt_pk_bf16_f32 v39, v74, v75
    ds_write_b128 v19, v[36:39] offset:64
    v_lshlrev_b32 v76, 16, v40
    v_and_b32 v77, 0xffff0000, v40
    v_lshlrev_b32 v78, 16, v41
    v_and_b32 v79, 0xffff0000, v41
    v_lshlrev_b32 v80, 16, v42
    v_and_b32 v81, 0xffff0000, v42
    v_lshlrev_b32 v82, 16, v43
    v_and_b32 v83, 0xffff0000, v43
    v_pk_fma_f32 v[76:77], v[76:77], s[88:89], s[88:89] op_sel:[0,0,1] op_sel_hi:[1,0,1]
    v_pk_fma_f32 v[78:79], v[78:79], s[88:89], s[88:89] op_sel:[0,0,1] op_sel_hi:[1,0,1]
    v_pk_fma_f32 v[80:81], v[80:81], s[88:89], s[88:89] op_sel:[0,0,1] op_sel_hi:[1,0,1]
    v_pk_fma_f32 v[82:83], v[82:83], s[88:89], s[88:89] op_sel:[0,0,1] op_sel_hi:[1,0,1]
    v_cvt_pk_bf16_f32 v40, v76, v77
    v_cvt_pk_bf16_f32 v41, v78, v79
    v_cvt_pk_bf16_f32 v42, v80, v81
    v_cvt_pk_bf16_f32 v43, v82, v83
    ds_write_b128 v19, v[40:43] offset:80
    v_lshlrev_b32 v68, 16, v44
    v_and_b32 v69, 0xffff0000, v44
    v_lshlrev_b32 v70, 16, v45
    v_and_b32 v71, 0xffff0000, v45
    v_lshlrev_b32 v72, 16, v46
    v_and_b32 v73, 0xffff0000, v46
    v_lshlrev_b32 v74, 16, v47
    v_and_b32 v75, 0xffff0000, v47
    v_pk_fma_f32 v[68:69], v[68:69], s[90:91], s[90:91] op_sel:[0,0,1] op_sel_hi:[1,0,1]
    v_pk_fma_f32 v[70:71], v[70:71], s[90:91], s[90:91] op_sel:[0,0,1] op_sel_hi:[1,0,1]
    v_pk_fma_f32 v[72:73], v[72:73], s[90:91], s[90:91] op_sel:[0,0,1] op_sel_hi:[1,0,1]
    v_pk_fma_f32 v[74:75], v[74:75], s[90:91], s[90:91] op_sel:[0,0,1] op_sel_hi:[1,0,1]
    v_cvt_pk_bf16_f32 v44, v68, v69
    v_cvt_pk_bf16_f32 v45, v70, v71
    v_cvt_pk_bf16_f32 v46, v72, v73
    v_cvt_pk_bf16_f32 v47, v74, v75
    ds_write_b128 v19, v[44:47] offset:96
    v_lshlrev_b32 v76, 16, v48
    v_and_b32 v77, 0xffff0000, v48
    v_lshlrev_b32 v78, 16, v49
    v_and_b32 v79, 0xffff0000, v49
    v_lshlrev_b32 v80, 16, v50
    v_and_b32 v81, 0xffff0000, v50
    v_lshlrev_b32 v82, 16, v51
    v_and_b32 v83, 0xffff0000, v51
    v_pk_fma_f32 v[76:77], v[76:77], s[92:93], s[92:93] op_sel:[0,0,1] op_sel_hi:[1,0,1]
    v_pk_fma_f32 v[78:79], v[78:79], s[92:93], s[92:93] op_sel:[0,0,1] op_sel_hi:[1,0,1]
    v_pk_fma_f32 v[80:81], v[80:81], s[92:93], s[92:93] op_sel:[0,0,1] op_sel_hi:[1,0,1]
    v_pk_fma_f32 v[82:83], v[82:83], s[92:93], s[92:93] op_sel:[0,0,1] op_sel_hi:[1,0,1]
    v_cvt_pk_bf16_f32 v48, v76, v77
    v_cvt_pk_bf16_f32 v49, v78, v79
    v_cvt_pk_bf16_f32 v50, v80, v81
    v_cvt_pk_bf16_f32 v51, v82, v83
    ds_write_b128 v19, v[48:51] offset:112
    s_cmp_lt_u32 s16, 4
    s_cbranch_scc1 L_k1_comp_5
    s_add_u32 s54, s63, 49152
    s_mov_b32 m0, s54
    s_nop 0
    buffer_load_dwordx4 v16, s[20:23], s62 offen offset:0 lds
    s_add_u32 s54, s63, 52224
    s_mov_b32 m0, s54
    s_nop 0
    buffer_load_dwordx4 v16, s[20:23], s62 offen offset:1024 lds
    s_add_u32 s54, s63, 55296
    s_mov_b32 m0, s54
    s_nop 0
    buffer_load_dwordx4 v16, s[20:23], s62 offen offset:2048 lds
    s_add_u32 s62, s62, 98304
    s_add_u32 s48, s63, 61440
    s_add_u32 s39, s63, 86016
    v_mov_b32 v18, 0
    s_waitcnt lgkmcnt(0)
    s_cmp_ge_u32 s47, 6
    s_cbranch_scc1 L_noflag_7
    s_waitcnt vmcnt(9)
    s_mov_b32 s38, 1
    s_atomic_add s38, s[94:95], 0x0
L_noflag_7:
    s_mov_b32 s47, 11
L_k1ld_6:
    s_waitcnt vmcnt(12)
    s_barrier
    s_add_u32 s54, s48, 0
    s_mov_b32 m0, s54
    s_nop 0
    buffer_load_dwordx4 v16, s[20:23], s62 offen offset:0 lds
    s_add_u32 s54, s48, 3072
    s_mov_b32 m0, s54
    s_nop 0
    buffer_load_dwordx4 v16, s[20:23], s62 offen offset:1024 lds
    s_add_u32 s54, s48, 6144
    s_mov_b32 m0, s54
    s_nop 0
    buffer_load_dwordx4 v16, s[20:23], s62 offen offset:2048 lds
    s_add_u32 s62, s62, 98304
    s_add_u32 s48, s48, 12288
    s_cmp_eq_u32 s48, s39
    s_cselect_b32 s48, s63, s48
    s_sub_u32 s47, s47, 1
    s_cmp_lg_u32 s47, 0
    s_cbranch_scc1 L_k1ld_6
    global_load_dword v85, v18, s[94:95] sc1
    v_lshlrev_b32 v17, 21, v0
    s_mov_b32 s54, 0x9fff80
    s_mov_b64 exec, 0xf
    buffer_load_dword v14, v17, s[4:7], s54 offen sc1
    s_mov_b64 exec, -1
    s_waitcnt vmcnt(14)
    s_barrier
    s_waitcnt vmcnt(11)
    s_barrier
    s_waitcnt vmcnt(8)
    s_barrier
    s_waitcnt vmcnt(5)
    s_barrier
    s_waitcnt vmcnt(2)
    s_barrier
    s_mov_b32 s39, 1048576
    s_waitcnt vmcnt(0)
L_zpoll_8:
    v_cmp_gt_u32 vcc, 6, v85
    s_sub_u32 s39, s39, 1
    s_cmp_eq_u32 s39, 0
    s_cbranch_scc1 L_zok_9
    s_cbranch_vccz L_zok_9
    global_load_dword v85, v18, s[94:95] sc1
    s_waitcnt vmcnt(0)
    s_branch L_zpoll_8
L_zok_9:
    s_branch L_att_2
L_k1_comp_5:
    v_mov_b32 v15, v207
    s_lshl_b32 s48, s44, 9
    s_waitcnt vmcnt(0) lgkmcnt(0)
    s_barrier
    ds_read_b128 v[164:167], v86 offset:0
    ds_read_b128 v[168:171], v86 offset:256
    ds_read_b64_tr_b16 v[140:141], v88 offset:0
    ds_read_b64_tr_b16 v[142:143], v88 offset:512
    ds_read_b64_tr_b16 v[144:145], v90 offset:0
    ds_read_b64_tr_b16 v[146:147], v90 offset:512
    ds_read_b64_tr_b16 v[148:149], v88 offset:4096
    ds_read_b64_tr_b16 v[150:151], v88 offset:4608
    ds_read_b64_tr_b16 v[152:153], v90 offset:4096
    ds_read_b64_tr_b16 v[154:155], v90 offset:4608
    ds_read_b64_tr_b16 v[156:157], v88 offset:8192
    ds_read_b64_tr_b16 v[158:159], v88 offset:8704
    s_waitcnt lgkmcnt(8)
    v_mfma_f32_16x16x32_bf16 v[92:95], v[140:143], v[164:167], 0
    ds_read_b64_tr_b16 v[160:161], v90 offset:8192
    ds_read_b64_tr_b16 v[162:163], v90 offset:8704
    v_mfma_f32_16x16x32_bf16 v[96:99], v[140:143], v[168:171], 0
    s_waitcnt lgkmcnt(8)
    v_mfma_f32_16x16x32_bf16 v[100:103], v[144:147], v[164:167], 0
    s_barrier
    ds_read_b128 v[172:175], v86 offset:2080
    ds_read_b128 v[176:179], v86 offset:2336
    ds_read_b64_tr_b16 v[140:141], v88 offset:12288
    ds_read_b64_tr_b16 v[142:143], v88 offset:12800
    v_mfma_f32_16x16x32_bf16 v[104:107], v[144:147], v[168:171], 0
    s_waitcnt lgkmcnt(10)
    v_mfma_f32_16x16x32_bf16 v[108:111], v[148:151], v[164:167], 0
    ds_read_b64_tr_b16 v[144:145], v90 offset:12288
    ds_read_b64_tr_b16 v[146:147], v90 offset:12800
    v_mfma_f32_16x16x32_bf16 v[112:115], v[148:151], v[168:171], 0
    s_waitcnt lgkmcnt(10)
    v_mfma_f32_16x16x32_bf16 v[116:119], v[152:155], v[164:167], 0
    ds_read_b64_tr_b16 v[148:149], v88 offset:16384
    ds_read_b64_tr_b16 v[150:151], v88 offset:16896
    v_mfma_f32_16x16x32_bf16 v[120:123], v[152:155], v[168:171], 0
    s_waitcnt lgkmcnt(10)
    v_mfma_f32_16x16x32_bf16 v[124:127], v[164:167], v[156:159], 0
    ds_read_b64_tr_b16 v[152:153], v90 offset:16384
    ds_read_b64_tr_b16 v[154:155], v90 offset:16896
    v_mfma_f32_16x16x32_bf16 v[128:131], v[168:171], v[156:159], 0
    s_waitcnt lgkmcnt(10)
    v_mfma_f32_16x16x32_bf16 v[132:135], v[164:167], v[160:163], 0
    ds_read_b64_tr_b16 v[156:157], v88 offset:20480
    ds_read_b64_tr_b16 v[158:159], v88 offset:20992
    v_mfma_f32_16x16x32_bf16 v[136:139], v[168:171], v[160:163], 0
    s_waitcnt lgkmcnt(8)
    v_mfma_f32_16x16x32_bf16 v[92:95], v[140:143], v[172:175], v[92:95]
    ds_read_b64_tr_b16 v[160:161], v90 offset:20480
    ds_read_b64_tr_b16 v[162:163], v90 offset:20992
    v_mfma_f32_16x16x32_bf16 v[96:99], v[140:143], v[176:179], v[96:99]
    s_waitcnt lgkmcnt(8)
    v_mfma_f32_16x16x32_bf16 v[100:103], v[144:147], v[172:175], v[100:103]
    s_barrier
    ds_read_b128 v[180:183], v86 offset:4160
    ds_read_b128 v[184:187], v86 offset:4416
    ds_read_b64_tr_b16 v[140:141], v88 offset:24576
    ds_read_b64_tr_b16 v[142:143], v88 offset:25088
    v_mfma_f32_16x16x32_bf16 v[104:107], v[144:147], v[176:179], v[104:107]
    s_waitcnt lgkmcnt(10)
    v_mfma_f32_16x16x32_bf16 v[108:111], v[148:151], v[172:175], v[108:111]
    ds_read_b64_tr_b16 v[144:145], v90 offset:24576
    ds_read_b64_tr_b16 v[146:147], v90 offset:25088
    v_mfma_f32_16x16x32_bf16 v[112:115], v[148:151], v[176:179], v[112:115]
    s_waitcnt lgkmcnt(10)
    v_mfma_f32_16x16x32_bf16 v[116:119], v[152:155], v[172:175], v[116:119]
    ds_read_b64_tr_b16 v[148:149], v88 offset:28672
    ds_read_b64_tr_b16 v[150:151], v88 offset:29184
    v_mfma_f32_16x16x32_bf16 v[120:123], v[152:155], v[176:179], v[120:123]
    s_waitcnt lgkmcnt(10)
    v_mfma_f32_16x16x32_bf16 v[124:127], v[172:175], v[156:159], v[124:127]
    ds_read_b64_tr_b16 v[152:153], v90 offset:28672
    ds_read_b64_tr_b16 v[154:155], v90 offset:29184
    v_mfma_f32_16x16x32_bf16 v[128:131], v[176:179], v[156:159], v[128:131]
    s_waitcnt lgkmcnt(10)
    v_mfma_f32_16x16x32_bf16 v[132:135], v[172:175], v[160:163], v[132:135]
    ds_read_b64_tr_b16 v[156:157], v88 offset:32768
    ds_read_b64_tr_b16 v[158:159], v88 offset:33280
    v_mfma_f32_16x16x32_bf16 v[136:139], v[176:179], v[160:163], v[136:139]
    s_waitcnt lgkmcnt(8)
    v_mfma_f32_16x16x32_bf16 v[92:95], v[140:143], v[180:183], v[92:95]
    ds_read_b64_tr_b16 v[160:161], v90 offset:32768
    ds_read_b64_tr_b16 v[162:163], v90 offset:33280
    v_mfma_f32_16x16x32_bf16 v[96:99], v[140:143], v[184:187], v[96:99]
    s_waitcnt lgkmcnt(8)
    v_mfma_f32_16x16x32_bf16 v[100:103], v[144:147], v[180:183], v[100:103]
    s_barrier
    ds_read_b128 v[188:191], v86 offset:6240
    ds_read_b128 v[192:195], v86 offset:6496
    ds_read_b64_tr_b16 v[140:141], v88 offset:36864
    ds_read_b64_tr_b16 v[142:143], v88 offset:37376
    v_mfma_f32_16x16x32_bf16 v[104:107], v[144:147], v[184:187], v[104:107]
    s_waitcnt lgkmcnt(10)
    v_mfma_f32_16x16x32_bf16 v[108:111], v[148:151], v[180:183], v[108:111]
    ds_read_b64_tr_b16 v[144:145], v90 offset:36864
    ds_read_b64_tr_b16 v[146:147], v90 offset:37376
    v_mfma_f32_16x16x32_bf16 v[112:115], v[148:151], v[184:187], v[112:115]
    s_waitcnt lgkmcnt(10)
    v_mfma_f32_16x16x32_bf16 v[116:119], v[152:155], v[180:183], v[116:119]
    ds_read_b64_tr_b16 v[148:149], v88 offset:40960
    ds_read_b64_tr_b16 v[150:151], v88 offset:41472
    v_mfma_f32_16x16x32_bf16 v[120:123], v[152:155], v[184:187], v[120:123]
    s_waitcnt lgkmcnt(10)
    v_mfma_f32_16x16x32_bf16 v[124:127], v[180:183], v[156:159], v[124:127]
    ds_read_b64_tr_b16 v[152:153], v90 offset:40960
    ds_read_b64_tr_b16 v[154:155], v90 offset:41472
    v_mfma_f32_16x16x32_bf16 v[128:131], v[184:187], v[156:159], v[128:131]
    s_waitcnt lgkmcnt(10)
    v_mfma_f32_16x16x32_bf16 v[132:135], v[180:183], v[160:163], v[132:135]
    ds_read_b64_tr_b16 v[156:157], v88 offset:45056
    ds_read_b64_tr_b16 v[158:159], v88 offset:45568
    v_mfma_f32_16x16x32_bf16 v[136:139], v[184:187], v[160:163], v[136:139]
    s_waitcnt lgkmcnt(8)
    v_mfma_f32_16x16x32_bf16 v[92:95], v[140:143], v[188:191], v[92:95]
    ds_read_b64_tr_b16 v[160:161], v90 offset:45056
    ds_read_b64_tr_b16 v[162:163], v90 offset:45568
    v_mfma_f32_16x16x32_bf16 v[96:99], v[140:143], v[192:195], v[96:99]
    s_waitcnt lgkmcnt(8)
    v_mfma_f32_16x16x32_bf16 v[100:103], v[144:147], v[188:191], v[100:103]
    s_barrier
    ds_read_b128 v[196:199], v86 offset:8320
    ds_read_b128 v[200:203], v86 offset:8576
    ds_read_b64_tr_b16 v[140:141], v88 offset:49152
    ds_read_b64_tr_b16 v[142:143], v88 offset:49664
    v_mfma_f32_16x16x32_bf16 v[104:107], v[144:147], v[192:195], v[104:107]
    s_waitcnt lgkmcnt(10)
    v_mfma_f32_16x16x32_bf16 v[108:111], v[148:151], v[188:191], v[108:111]
    ds_read_b64_tr_b16 v[144:145], v90 offset:49152
    ds_read_b64_tr_b16 v[146:147], v90 offset:49664
    v_mfma_f32_16x16x32_bf16 v[112:115], v[148:151], v[192:195], v[112:115]
    s_waitcnt lgkmcnt(10)
    v_mfma_f32_16x16x32_bf16 v[116:119], v[152:155], v[188:191], v[116:119]
    ds_read_b64_tr_b16 v[148:149], v88 offset:53248
    ds_read_b64_tr_b16 v[150:151], v88 offset:53760
    v_mfma_f32_16x16x32_bf16 v[120:123], v[152:155], v[192:195], v[120:123]
    s_waitcnt lgkmcnt(10)
    v_mfma_f32_16x16x32_bf16 v[124:127], v[188:191], v[156:159], v[124:127]
    ds_read_b64_tr_b16 v[152:153], v90 offset:53248
    ds_read_b64_tr_b16 v[154:155], v90 offset:53760
    v_mfma_f32_16x16x32_bf16 v[128:131], v[192:195], v[156:159], v[128:131]
    s_waitcnt lgkmcnt(10)
    v_mfma_f32_16x16x32_bf16 v[132:135], v[188:191], v[160:163], v[132:135]
    ds_read_b64_tr_b16 v[156:157], v88 offset:57344
    ds_read_b64_tr_b16 v[158:159], v88 offset:57856
    v_mfma_f32_16x16x32_bf16 v[136:139], v[192:195], v[160:163], v[136:139]
    s_waitcnt lgkmcnt(8)
    v_mfma_f32_16x16x32_bf16 v[92:95], v[140:143], v[196:199], v[92:95]
    ds_read_b64_tr_b16 v[160:161], v90 offset:57344
    ds_read_b64_tr_b16 v[162:163], v90 offset:57856
    v_mfma_f32_16x16x32_bf16 v[96:99], v[140:143], v[200:203], v[96:99]
    s_waitcnt lgkmcnt(8)
    v_mfma_f32_16x16x32_bf16 v[100:103], v[144:147], v[196:199], v[100:103]
    s_barrier
    ds_read_b128 v[164:167], v86 offset:10400
    ds_read_b128 v[168:171], v86 offset:10656
    ds_read_b64_tr_b16 v[140:141], v88 offset:61440
    ds_read_b64_tr_b16 v[142:143], v88 offset:61952
    v_mfma_f32_16x16x32_bf16 v[104:107], v[144:147], v[200:203], v[104:107]
    s_waitcnt lgkmcnt(10)
    v_mfma_f32_16x16x32_bf16 v[108:111], v[148:151], v[196:199], v[108:111]
    ds_read_b64_tr_b16 v[144:145], v90 offset:61440
    ds_read_b64_tr_b16 v[146:147], v90 offset:61952
    v_mfma_f32_16x16x32_bf16 v[112:115], v[148:151], v[200:203], v[112:115]
    s_waitcnt lgkmcnt(10)
    v_mfma_f32_16x16x32_bf16 v[116:119], v[152:155], v[196:199], v[116:119]
    ds_read_b64_tr_b16 v[148:149], v89 offset:0
    ds_read_b64_tr_b16 v[150:151], v89 offset:512
    v_mfma_f32_16x16x32_bf16 v[120:123], v[152:155], v[200:203], v[120:123]
    s_waitcnt lgkmcnt(10)
    v_mfma_f32_16x16x32_bf16 v[124:127], v[196:199], v[156:159], v[124:127]
    ds_read_b64_tr_b16 v[152:153], v91 offset:0
    ds_read_b64_tr_b16 v[154:155], v91 offset:512
    v_mfma_f32_16x16x32_bf16 v[128:131], v[200:203], v[156:159], v[128:131]
    s_waitcnt lgkmcnt(10)
    v_mfma_f32_16x16x32_bf16 v[132:135], v[196:199], v[160:163], v[132:135]
    ds_read_b64_tr_b16 v[156:157], v89 offset:4096
    ds_read_b64_tr_b16 v[158:159], v89 offset:4608
    v_mfma_f32_16x16x32_bf16 v[136:139], v[200:203], v[160:163], v[136:139]
    s_waitcnt lgkmcnt(8)
    v_mfma_f32_16x16x32_bf16 v[92:95], v[140:143], v[164:167], v[92:95]
    ds_read_b64_tr_b16 v[160:161], v91 offset:4096
    ds_read_b64_tr_b16 v[162:163], v91 offset:4608
    v_mfma_f32_16x16x32_bf16 v[96:99], v[140:143], v[168:171], v[96:99]
    s_waitcnt lgkmcnt(8)
    v_mfma_f32_16x16x32_bf16 v[100:103], v[144:147], v[164:167], v[100:103]
    s_barrier
    ds_read_b128 v[172:175], v86 offset:12480
    ds_read_b128 v[176:179], v86 offset:12736
    ds_read_b64_tr_b16 v[140:141], v89 offset:8192
    ds_read_b64_tr_b16 v[142:143], v89 offset:8704
    v_mfma_f32_16x16x32_bf16 v[104:107], v[144:147], v[168:171], v[104:107]
    s_waitcnt lgkmcnt(10)
    v_mfma_f32_16x16x32_bf16 v[108:111], v[148:151], v[164:167], v[108:111]
    ds_read_b64_tr_b16 v[144:145], v91 offset:8192
    ds_read_b64_tr_b16 v[146:147], v91 offset:8704
    v_mfma_f32_16x16x32_bf16 v[112:115], v[148:151], v[168:171], v[112:115]
    s_waitcnt lgkmcnt(10)
    v_mfma_f32_16x16x32_bf16 v[116:119], v[152:155], v[164:167], v[116:119]
    ds_read_b64_tr_b16 v[148:149], v89 offset:12288
    ds_read_b64_tr_b16 v[150:151], v89 offset:12800
    v_mfma_f32_16x16x32_bf16 v[120:123], v[152:155], v[168:171], v[120:123]
    s_waitcnt lgkmcnt(10)
    v_mfma_f32_16x16x32_bf16 v[124:127], v[164:167], v[156:159], v[124:127]
    ds_read_b64_tr_b16 v[152:153], v91 offset:12288
    ds_read_b64_tr_b16 v[154:155], v91 offset:12800
    v_mfma_f32_16x16x32_bf16 v[128:131], v[168:171], v[156:159], v[128:131]
    s_waitcnt lgkmcnt(10)
    v_mfma_f32_16x16x32_bf16 v[132:135], v[164:167], v[160:163], v[132:135]
    ds_read_b64_tr_b16 v[156:157], v89 offset:16384
    ds_read_b64_tr_b16 v[158:159], v89 offset:16896
    v_mfma_f32_16x16x32_bf16 v[136:139], v[168:171], v[160:163], v[136:139]
    s_waitcnt lgkmcnt(8)
    v_mfma_f32_16x16x32_bf16 v[92:95], v[140:143], v[172:175], v[92:95]
    ds_read_b64_tr_b16 v[160:161], v91 offset:16384
    ds_read_b64_tr_b16 v[162:163], v91 offset:16896
    v_mfma_f32_16x16x32_bf16 v[96:99], v[140:143], v[176:179], v[96:99]
    s_waitcnt lgkmcnt(8)
    v_mfma_f32_16x16x32_bf16 v[100:103], v[144:147], v[172:175], v[100:103]
    s_barrier
    ds_read_b128 v[180:183], v86 offset:14560
    ds_read_b128 v[184:187], v86 offset:14816
    ds_read_b64_tr_b16 v[140:141], v88 offset:0
    ds_read_b64_tr_b16 v[142:143], v88 offset:512
    v_mfma_f32_16x16x32_bf16 v[104:107], v[144:147], v[176:179], v[104:107]
    s_waitcnt lgkmcnt(10)
    v_mfma_f32_16x16x32_bf16 v[108:111], v[148:151], v[172:175], v[108:111]
    ds_read_b64_tr_b16 v[144:145], v90 offset:0
    ds_read_b64_tr_b16 v[146:147], v90 offset:512
    v_mfma_f32_16x16x32_bf16 v[112:115], v[148:151], v[176:179], v[112:115]
    s_waitcnt lgkmcnt(10)
    v_mfma_f32_16x16x32_bf16 v[116:119], v[152:155], v[172:175], v[116:119]
    ds_read_b64_tr_b16 v[148:149], v88 offset:4096
    ds_read_b64_tr_b16 v[150:151], v88 offset:4608
    v_mfma_f32_16x16x32_bf16 v[120:123], v[152:155], v[176:179], v[120:123]
    s_waitcnt lgkmcnt(10)
    v_mfma_f32_16x16x32_bf16 v[124:127], v[172:175], v[156:159], v[124:127]
    ds_read_b64_tr_b16 v[152:153], v90 offset:4096
    ds_read_b64_tr_b16 v[154:155], v90 offset:4608
    v_mfma_f32_16x16x32_bf16 v[128:131], v[176:179], v[156:159], v[128:131]
    s_waitcnt lgkmcnt(10)
    v_mfma_f32_16x16x32_bf16 v[132:135], v[172:175], v[160:163], v[132:135]
    ds_read_b64_tr_b16 v[156:157], v88 offset:8192
    ds_read_b64_tr_b16 v[158:159], v88 offset:8704
    v_mfma_f32_16x16x32_bf16 v[136:139], v[176:179], v[160:163], v[136:139]
    s_waitcnt lgkmcnt(8)
    v_mfma_f32_16x16x32_bf16 v[92:95], v[140:143], v[180:183], v[92:95]
    ds_read_b64_tr_b16 v[160:161], v90 offset:8192
    ds_read_b64_tr_b16 v[162:163], v90 offset:8704
    v_mfma_f32_16x16x32_bf16 v[96:99], v[140:143], v[184:187], v[96:99]
    s_waitcnt lgkmcnt(8)
    v_mfma_f32_16x16x32_bf16 v[100:103], v[144:147], v[180:183], v[100:103]
    s_barrier
    ds_read_b128 v[188:191], v86 offset:16640
    ds_read_b128 v[192:195], v86 offset:16896
    ds_read_b64_tr_b16 v[140:141], v88 offset:12288
    ds_read_b64_tr_b16 v[142:143], v88 offset:12800
    v_mfma_f32_16x16x32_bf16 v[104:107], v[144:147], v[184:187], v[104:107]
    s_waitcnt lgkmcnt(10)
    v_mfma_f32_16x16x32_bf16 v[108:111], v[148:151], v[180:183], v[108:111]
    ds_read_b64_tr_b16 v[144:145], v90 offset:12288
    ds_read_b64_tr_b16 v[146:147], v90 offset:12800
    v_mfma_f32_16x16x32_bf16 v[112:115], v[148:151], v[184:187], v[112:115]
    s_waitcnt lgkmcnt(10)
    v_mfma_f32_16x16x32_bf16 v[116:119], v[152:155], v[180:183], v[116:119]
    ds_read_b64_tr_b16 v[148:149], v88 offset:16384
    ds_read_b64_tr_b16 v[150:151], v88 offset:16896
    v_mfma_f32_16x16x32_bf16 v[120:123], v[152:155], v[184:187], v[120:123]
    s_waitcnt lgkmcnt(10)
    v_mfma_f32_16x16x32_bf16 v[124:127], v[180:183], v[156:159], v[124:127]
    ds_read_b64_tr_b16 v[152:153], v90 offset:16384
    ds_read_b64_tr_b16 v[154:155], v90 offset:16896
    v_mfma_f32_16x16x32_bf16 v[128:131], v[184:187], v[156:159], v[128:131]
    s_waitcnt lgkmcnt(10)
    v_mfma_f32_16x16x32_bf16 v[132:135], v[180:183], v[160:163], v[132:135]
    ds_read_b64_tr_b16 v[156:157], v88 offset:20480
    ds_read_b64_tr_b16 v[158:159], v88 offset:20992
    v_mfma_f32_16x16x32_bf16 v[136:139], v[184:187], v[160:163], v[136:139]
    s_waitcnt lgkmcnt(8)
    v_mfma_f32_16x16x32_bf16 v[92:95], v[140:143], v[188:191], v[92:95]
    ds_read_b64_tr_b16 v[160:161], v90 offset:20480
    ds_read_b64_tr_b16 v[162:163], v90 offset:20992
    v_mfma_f32_16x16x32_bf16 v[96:99], v[140:143], v[192:195], v[96:99]
    s_waitcnt lgkmcnt(8)
    v_mfma_f32_16x16x32_bf16 v[100:103], v[144:147], v[188:191], v[100:103]
    s_barrier
    ds_read_b128 v[196:199], v86 offset:18720
    ds_read_b128 v[200:203], v86 offset:18976
    ds_read_b64_tr_b16 v[140:141], v88 offset:24576
    ds_read_b64_tr_b16 v[142:143], v88 offset:25088
    v_mfma_f32_16x16x32_bf16 v[104:107], v[144:147], v[192:195], v[104:107]
    s_waitcnt lgkmcnt(10)
    v_mfma_f32_16x16x32_bf16 v[108:111], v[148:151], v[188:191], v[108:111]
    ds_read_b64_tr_b16 v[144:145], v90 offset:24576
    ds_read_b64_tr_b16 v[146:147], v90 offset:25088
    v_mfma_f32_16x16x32_bf16 v[112:115], v[148:151], v[192:195], v[112:115]
    s_waitcnt lgkmcnt(10)
    v_mfma_f32_16x16x32_bf16 v[116:119], v[152:155], v[188:191], v[116:119]
    ds_read_b64_tr_b16 v[148:149], v88 offset:28672
    ds_read_b64_tr_b16 v[150:151], v88 offset:29184
    v_mfma_f32_16x16x32_bf16 v[120:123], v[152:155], v[192:195], v[120:123]
    s_waitcnt lgkmcnt(10)
    v_mfma_f32_16x16x32_bf16 v[124:127], v[188:191], v[156:159], v[124:127]
    ds_read_b64_tr_b16 v[152:153], v90 offset:28672
    ds_read_b64_tr_b16 v[154:155], v90 offset:29184
    v_mfma_f32_16x16x32_bf16 v[128:131], v[192:195], v[156:159], v[128:131]
    s_waitcnt lgkmcnt(10)
    v_mfma_f32_16x16x32_bf16 v[132:135], v[188:191], v[160:163], v[132:135]
    ds_read_b64_tr_b16 v[156:157], v88 offset:32768
    ds_read_b64_tr_b16 v[158:159], v88 offset:33280
    v_mfma_f32_16x16x32_bf16 v[136:139], v[192:195], v[160:163], v[136:139]
    s_waitcnt lgkmcnt(8)
    v_mfma_f32_16x16x32_bf16 v[92:95], v[140:143], v[196:199], v[92:95]
    ds_read_b64_tr_b16 v[160:161], v90 offset:32768
    ds_read_b64_tr_b16 v[162:163], v90 offset:33280
    v_mfma_f32_16x16x32_bf16 v[96:99], v[140:143], v[200:203], v[96:99]
    s_waitcnt lgkmcnt(8)
    v_mfma_f32_16x16x32_bf16 v[100:103], v[144:147], v[196:199], v[100:103]
    s_barrier
    ds_read_b128 v[164:167], v86 offset:20800
    ds_read_b128 v[168:171], v86 offset:21056
    ds_read_b64_tr_b16 v[140:141], v88 offset:36864
    ds_read_b64_tr_b16 v[142:143], v88 offset:37376
    v_mfma_f32_16x16x32_bf16 v[104:107], v[144:147], v[200:203], v[104:107]
    s_waitcnt lgkmcnt(10)
    v_mfma_f32_16x16x32_bf16 v[108:111], v[148:151], v[196:199], v[108:111]
    ds_read_b64_tr_b16 v[144:145], v90 offset:36864
    ds_read_b64_tr_b16 v[146:147], v90 offset:37376
    v_mfma_f32_16x16x32_bf16 v[112:115], v[148:151], v[200:203], v[112:115]
    s_waitcnt lgkmcnt(10)
    v_mfma_f32_16x16x32_bf16 v[116:119], v[152:155], v[196:199], v[116:119]
    ds_read_b64_tr_b16 v[148:149], v88 offset:40960
    ds_read_b64_tr_b16 v[150:151], v88 offset:41472
    v_mfma_f32_16x16x32_bf16 v[120:123], v[152:155], v[200:203], v[120:123]
    s_waitcnt lgkmcnt(10)
    v_mfma_f32_16x16x32_bf16 v[124:127], v[196:199], v[156:159], v[124:127]
    ds_read_b64_tr_b16 v[152:153], v90 offset:40960
    ds_read_b64_tr_b16 v[154:155], v90 offset:41472
    v_mfma_f32_16x16x32_bf16 v[128:131], v[200:203], v[156:159], v[128:131]
    s_waitcnt lgkmcnt(10)
    v_mfma_f32_16x16x32_bf16 v[132:135], v[196:199], v[160:163], v[132:135]
    ds_read_b64_tr_b16 v[156:157], v88 offset:45056
    ds_read_b64_tr_b16 v[158:159], v88 offset:45568
    v_mfma_f32_16x16x32_bf16 v[136:139], v[200:203], v[160:163], v[136:139]
    s_waitcnt lgkmcnt(8)
    v_mfma_f32_16x16x32_bf16 v[92:95], v[140:143], v[164:167], v[92:95]
    ds_read_b64_tr_b16 v[160:161], v90 offset:45056
    ds_read_b64_tr_b16 v[162:163], v90 offset:45568
    v_mfma_f32_16x16x32_bf16 v[96:99], v[140:143], v[168:171], v[96:99]
    s_waitcnt lgkmcnt(8)
    v_mfma_f32_16x16x32_bf16 v[100:103], v[144:147], v[164:167], v[100:103]
    s_barrier
    ds_read_b128 v[172:175], v86 offset:22880
    ds_read_b128 v[176:179], v86 offset:23136
    ds_read_b64_tr_b16 v[140:141], v88 offset:49152
    ds_read_b64_tr_b16 v[142:143], v88 offset:49664
    v_mfma_f32_16x16x32_bf16 v[104:107], v[144:147], v[168:171], v[104:107]
    s_waitcnt lgkmcnt(10)
    v_mfma_f32_16x16x32_bf16 v[108:111], v[148:151], v[164:167], v[108:111]
    ds_read_b64_tr_b16 v[144:145], v90 offset:49152
    ds_read_b64_tr_b16 v[146:147], v90 offset:49664
    v_mfma_f32_16x16x32_bf16 v[112:115], v[148:151], v[168:171], v[112:115]
    s_waitcnt lgkmcnt(10)
    v_mfma_f32_16x16x32_bf16 v[116:119], v[152:155], v[164:167], v[116:119]
    ds_read_b64_tr_b16 v[148:149], v88 offset:53248
    ds_read_b64_tr_b16 v[150:151], v88 offset:53760
    v_mfma_f32_16x16x32_bf16 v[120:123], v[152:155], v[168:171], v[120:123]
    s_waitcnt lgkmcnt(10)
    v_mfma_f32_16x16x32_bf16 v[124:127], v[164:167], v[156:159], v[124:127]
    ds_read_b64_tr_b16 v[152:153], v90 offset:53248
    ds_read_b64_tr_b16 v[154:155], v90 offset:53760
    v_mfma_f32_16x16x32_bf16 v[128:131], v[168:171], v[156:159], v[128:131]
    s_waitcnt lgkmcnt(10)
    v_mfma_f32_16x16x32_bf16 v[132:135], v[164:167], v[160:163], v[132:135]
    ds_read_b64_tr_b16 v[156:157], v88 offset:57344
    ds_read_b64_tr_b16 v[158:159], v88 offset:57856
    v_mfma_f32_16x16x32_bf16 v[136:139], v[168:171], v[160:163], v[136:139]
    s_waitcnt lgkmcnt(8)
    v_mfma_f32_16x16x32_bf16 v[92:95], v[140:143], v[172:175], v[92:95]
    ds_read_b64_tr_b16 v[160:161], v90 offset:57344
    ds_read_b64_tr_b16 v[162:163], v90 offset:57856
    v_mfma_f32_16x16x32_bf16 v[96:99], v[140:143], v[176:179], v[96:99]
    s_waitcnt lgkmcnt(8)
    v_mfma_f32_16x16x32_bf16 v[100:103], v[144:147], v[172:175], v[100:103]
    s_barrier
    ds_read_b128 v[180:183], v86 offset:24960
    ds_read_b128 v[184:187], v86 offset:25216
    ds_read_b64_tr_b16 v[140:141], v89 offset:4096
    ds_read_b64_tr_b16 v[142:143], v89 offset:4608
    v_mfma_f32_16x16x32_bf16 v[104:107], v[144:147], v[176:179], v[104:107]
    s_waitcnt lgkmcnt(10)
    v_mfma_f32_16x16x32_bf16 v[108:111], v[148:151], v[172:175], v[108:111]
    ds_read_b64_tr_b16 v[144:145], v91 offset:4096
    ds_read_b64_tr_b16 v[146:147], v91 offset:4608
    v_mfma_f32_16x16x32_bf16 v[112:115], v[148:151], v[176:179], v[112:115]
    s_waitcnt lgkmcnt(10)
    v_mfma_f32_16x16x32_bf16 v[116:119], v[152:155], v[172:175], v[116:119]
    s_barrier
    ds_read_b128 v[188:191], v86 offset:27040
    ds_read_b128 v[192:195], v86 offset:27296
    ds_read_b64_tr_b16 v[148:149], v89 offset:16384
    ds_read_b64_tr_b16 v[150:151], v89 offset:16896
    v_mfma_f32_16x16x32_bf16 v[120:123], v[152:155], v[176:179], v[120:123]
    s_waitcnt lgkmcnt(12)
    v_mfma_f32_16x16x32_bf16 v[124:127], v[172:175], v[156:159], v[124:127]
    ds_read_b64_tr_b16 v[152:153], v91 offset:16384
    ds_read_b64_tr_b16 v[154:155], v91 offset:16896
    v_mfma_f32_16x16x32_bf16 v[128:131], v[176:179], v[156:159], v[128:131]
    s_waitcnt lgkmcnt(12)
    v_mfma_f32_16x16x32_bf16 v[132:135], v[172:175], v[160:163], v[132:135]
    s_barrier
    ds_read_b128 v[196:199], v86 offset:29120
    ds_read_b128 v[200:203], v86 offset:29376
    ds_read_b64_tr_b16 v[156:157], v88 offset:8192
    ds_read_b64_tr_b16 v[158:159], v88 offset:8704
    v_mfma_f32_16x16x32_bf16 v[136:139], v[176:179], v[160:163], v[136:139]
    s_waitcnt lgkmcnt(12)
    v_mfma_f32_16x16x32_bf16 v[124:127], v[180:183], v[140:143], v[124:127]
    ds_read_b64_tr_b16 v[160:161], v90 offset:8192
    ds_read_b64_tr_b16 v[162:163], v90 offset:8704
    v_mfma_f32_16x16x32_bf16 v[128:131], v[184:187], v[140:143], v[128:131]
    s_waitcnt lgkmcnt(12)
    v_mfma_f32_16x16x32_bf16 v[132:135], v[180:183], v[144:147], v[132:135]
    s_barrier
    ds_read_b128 v[164:167], v86 offset:31200
    ds_read_b128 v[168:171], v86 offset:31456
    ds_read_b64_tr_b16 v[140:141], v88 offset:20480
    ds_read_b64_tr_b16 v[142:143], v88 offset:20992
    v_mfma_f32_16x16x32_bf16 v[136:139], v[184:187], v[144:147], v[136:139]
    s_waitcnt lgkmcnt(12)
    v_mfma_f32_16x16x32_bf16 v[124:127], v[188:191], v[148:151], v[124:127]
    ds_read_b64_tr_b16 v[144:145], v90 offset:20480
    ds_read_b64_tr_b16 v[146:147], v90 offset:20992
    v_mfma_f32_16x16x32_bf16 v[128:131], v[192:195], v[148:151], v[128:131]
    s_waitcnt lgkmcnt(12)
    v_mfma_f32_16x16x32_bf16 v[132:135], v[188:191], v[152:155], v[132:135]
    ds_read_b64_tr_b16 v[148:149], v89 offset:0
    ds_read_b64_tr_b16 v[150:151], v89 offset:512
    v_mfma_f32_16x16x32_bf16 v[136:139], v[192:195], v[152:155], v[136:139]
    s_waitcnt lgkmcnt(10)
    v_mfma_f32_16x16x32_bf16 v[124:127], v[196:199], v[156:159], v[124:127]
    ds_read_b64_tr_b16 v[152:153], v91 offset:0
    ds_read_b64_tr_b16 v[154:155], v91 offset:512
    v_mfma_f32_16x16x32_bf16 v[128:131], v[200:203], v[156:159], v[128:131]
    s_waitcnt lgkmcnt(10)
    v_mfma_f32_16x16x32_bf16 v[132:135], v[196:199], v[160:163], v[132:135]
    ds_read_b64_tr_b16 v[156:157], v89 offset:12288
    ds_read_b64_tr_b16 v[158:159], v89 offset:12800
    v_mfma_f32_16x16x32_bf16 v[136:139], v[200:203], v[160:163], v[136:139]
    s_waitcnt lgkmcnt(8)
    v_mfma_f32_16x16x32_bf16 v[124:127], v[164:167], v[140:143], v[124:127]
    ds_read_b64_tr_b16 v[160:161], v91 offset:12288
    ds_read_b64_tr_b16 v[162:163], v91 offset:12800
    v_mfma_f32_16x16x32_bf16 v[128:131], v[168:171], v[140:143], v[128:131]
    s_waitcnt lgkmcnt(8)
    v_mfma_f32_16x16x32_bf16 v[132:135], v[164:167], v[144:147], v[132:135]
    ds_read_b64_tr_b16 v[140:141], v88 offset:4096
    ds_read_b64_tr_b16 v[142:143], v88 offset:4608
    v_mfma_f32_16x16x32_bf16 v[136:139], v[168:171], v[144:147], v[136:139]
    s_waitcnt lgkmcnt(8)
    v_mfma_f32_16x16x32_bf16 v[108:111], v[148:151], v[180:183], v[108:111]
    ds_read_b64_tr_b16 v[144:145], v90 offset:4096
    ds_read_b64_tr_b16 v[146:147], v90 offset:4608
    v_mfma_f32_16x16x32_bf16 v[112:115], v[148:151], v[184:187], v[112:115]
    s_waitcnt lgkmcnt(8)
    v_mfma_f32_16x16x32_bf16 v[116:119], v[152:155], v[180:183], v[116:119]
    ds_read_b64_tr_b16 v[148:149], v88 offset:16384
    ds_read_b64_tr_b16 v[150:151], v88 offset:16896
    v_mfma_f32_16x16x32_bf16 v[120:123], v[152:155], v[184:187], v[120:123]
    s_waitcnt lgkmcnt(8)
    v_mfma_f32_16x16x32_bf16 v[108:111], v[156:159], v[188:191], v[108:111]
    ds_read_b64_tr_b16 v[152:153], v90 offset:16384
    ds_read_b64_tr_b16 v[154:155], v90 offset:16896
    v_mfma_f32_16x16x32_bf16 v[112:115], v[156:159], v[192:195], v[112:115]
    s_add_u32 s27, s30, 0xe00000
    v_cvt_pk_bf16_f32 v220, v124, v125
    v_cvt_pk_bf16_f32 v222, v128, v129
    v_cvt_pk_bf16_f32 v221, v126, v127
    v_cvt_pk_bf16_f32 v223, v130, v131
    buffer_store_dwordx4 v[220:223], v2, s[4:7], s27 offen sc1
    s_add_u32 s27, s30, 0xe10000
    v_cvt_pk_bf16_f32 v224, v132, v133
    v_cvt_pk_bf16_f32 v226, v136, v137
    v_cvt_pk_bf16_f32 v225, v134, v135
    v_cvt_pk_bf16_f32 v227, v138, v139
    buffer_store_dwordx4 v[224:227], v2, s[4:7], s27 offen sc1
    s_waitcnt lgkmcnt(8)
    v_mfma_f32_16x16x32_bf16 v[116:119], v[160:163], v[188:191], v[116:119]
    ds_read_b64_tr_b16 v[156:157], v88 offset:61440
    ds_read_b64_tr_b16 v[158:159], v88 offset:61952
    v_mfma_f32_16x16x32_bf16 v[120:123], v[160:163], v[192:195], v[120:123]
    s_waitcnt lgkmcnt(8)
    v_mfma_f32_16x16x32_bf16 v[108:111], v[140:143], v[196:199], v[108:111]
    ds_read_b64_tr_b16 v[160:161], v90 offset:61440
    ds_read_b64_tr_b16 v[162:163], v90 offset:61952
    v_mfma_f32_16x16x32_bf16 v[112:115], v[140:143], v[200:203], v[112:115]
    s_waitcnt lgkmcnt(8)
    v_mfma_f32_16x16x32_bf16 v[116:119], v[144:147], v[196:199], v[116:119]
    ds_read_b64_tr_b16 v[140:141], v89 offset:8192
    ds_read_b64_tr_b16 v[142:143], v89 offset:8704
    v_mfma_f32_16x16x32_bf16 v[120:123], v[144:147], v[200:203], v[120:123]
    s_waitcnt lgkmcnt(8)
    v_mfma_f32_16x16x32_bf16 v[108:111], v[148:151], v[164:167], v[108:111]
    ds_read_b64_tr_b16 v[144:145], v91 offset:8192
    ds_read_b64_tr_b16 v[146:147], v91 offset:8704
    v_mfma_f32_16x16x32_bf16 v[112:115], v[148:151], v[168:171], v[112:115]
    s_waitcnt lgkmcnt(8)
    v_mfma_f32_16x16x32_bf16 v[116:119], v[152:155], v[164:167], v[116:119]
    ds_read_b64_tr_b16 v[148:149], v88 offset:0
    ds_read_b64_tr_b16 v[150:151], v88 offset:512
    v_mfma_f32_16x16x32_bf16 v[120:123], v[152:155], v[168:171], v[120:123]
    s_waitcnt lgkmcnt(8)
    v_mfma_f32_16x16x32_bf16 v[92:95], v[156:159], v[180:183], v[92:95]
    ds_read_b64_tr_b16 v[152:153], v90 offset:0
    ds_read_b64_tr_b16 v[154:155], v90 offset:512
    v_mfma_f32_16x16x32_bf16 v[96:99], v[156:159], v[184:187], v[96:99]
    s_waitcnt lgkmcnt(8)
    v_mfma_f32_16x16x32_bf16 v[100:103], v[160:163], v[180:183], v[100:103]
    ds_read_b64_tr_b16 v[156:157], v88 offset:12288
    ds_read_b64_tr_b16 v[158:159], v88 offset:12800
    v_mfma_f32_16x16x32_bf16 v[104:107], v[160:163], v[184:187], v[104:107]
    s_waitcnt lgkmcnt(8)
    v_mfma_f32_16x16x32_bf16 v[92:95], v[140:143], v[188:191], v[92:95]
    ds_read_b64_tr_b16 v[160:161], v90 offset:12288
    ds_read_b64_tr_b16 v[162:163], v90 offset:12800
    v_mfma_f32_16x16x32_bf16 v[96:99], v[140:143], v[192:195], v[96:99]
    s_add_u32 s27, s30, 0xc00000
    v_cvt_pk_bf16_f32 v212, v108, v109
    v_cvt_pk_bf16_f32 v214, v112, v113
    v_cvt_pk_bf16_f32 v213, v110, v111
    v_cvt_pk_bf16_f32 v215, v114, v115
    v_permlane32_swap_b32 v212, v214
    s_nop 0
    v_permlane32_swap_b32 v213, v215
    buffer_store_dwordx4 v[212:215], v87, s[4:7], s27 offen sc1
    s_add_u32 s27, s30, 0xc10000
    v_cvt_pk_bf16_f32 v216, v116, v117
    v_cvt_pk_bf16_f32 v218, v120, v121
    v_cvt_pk_bf16_f32 v217, v118, v119
    v_cvt_pk_bf16_f32 v219, v122, v123
    v_permlane32_swap_b32 v216, v218
    s_nop 0
    v_permlane32_swap_b32 v217, v219
    buffer_store_dwordx4 v[216:219], v87, s[4:7], s27 offen sc1
    s_waitcnt lgkmcnt(8)
    v_mfma_f32_16x16x32_bf16 v[100:103], v[144:147], v[188:191], v[100:103]
    v_mfma_f32_16x16x32_bf16 v[104:107], v[144:147], v[192:195], v[104:107]
    s_waitcnt lgkmcnt(6)
    v_mfma_f32_16x16x32_bf16 v[92:95], v[148:151], v[196:199], v[92:95]
    v_mfma_f32_16x16x32_bf16 v[96:99], v[148:151], v[200:203], v[96:99]
    s_waitcnt lgkmcnt(4)
    v_mfma_f32_16x16x32_bf16 v[100:103], v[152:155], v[196:199], v[100:103]
    v_mfma_f32_16x16x32_bf16 v[104:107], v[152:155], v[200:203], v[104:107]
    s_waitcnt lgkmcnt(2)
    v_mfma_f32_16x16x32_bf16 v[92:95], v[156:159], v[164:167], v[92:95]
    v_mfma_f32_16x16x32_bf16 v[96:99], v[156:159], v[168:171], v[96:99]
    s_waitcnt lgkmcnt(0)
    v_mfma_f32_16x16x32_bf16 v[100:103], v[160:163], v[164:167], v[100:103]
    v_mfma_f32_16x16x32_bf16 v[104:107], v[160:163], v[168:171], v[104:107]
    s_nop 6
    s_add_u32 s27, s30, 0xa00000
    v_pk_mul_f32 v[92:93], v[92:93], s[28:29]
    v_pk_mul_f32 v[94:95], v[94:95], s[28:29]
    v_pk_mul_f32 v[96:97], v[96:97], s[28:29]
    v_pk_mul_f32 v[98:99], v[98:99], s[28:29]
    v_cvt_pk_bf16_f32 v204, v92, v93
    v_cvt_pk_bf16_f32 v206, v96, v97
    v_cvt_pk_bf16_f32 v205, v94, v95
    v_cvt_pk_bf16_f32 v207, v98, v99
    v_permlane32_swap_b32 v204, v206
    s_nop 0
    v_permlane32_swap_b32 v205, v207
    buffer_store_dwordx4 v[204:207], v87, s[4:7], s27 offen sc1
    s_add_u32 s27, s30, 0xa10000
    v_pk_mul_f32 v[100:101], v[100:101], s[28:29]
    v_pk_mul_f32 v[102:103], v[102:103], s[28:29]
    v_pk_mul_f32 v[104:105], v[104:105], s[28:29]
    v_pk_mul_f32 v[106:107], v[106:107], s[28:29]
    v_cvt_pk_bf16_f32 v208, v100, v101
    v_cvt_pk_bf16_f32 v210, v104, v105
    v_cvt_pk_bf16_f32 v209, v102, v103
    v_cvt_pk_bf16_f32 v211, v106, v107
    v_permlane32_swap_b32 v208, v210
    s_nop 0
    v_permlane32_swap_b32 v209, v211
    buffer_store_dwordx4 v[208:211], v87, s[4:7], s27 offen sc1
    s_branch L_att_2
L_att_2:
    s_and_b32 s43, s18, 3
    s_lshr_b32 s19, s17, 0
    s_lshl_b32 s19, s19, 2
    s_add_u32 s43, s43, s19
    s_lshl_b32 s43, s43, 1
    s_lshr_b32 s44, s18, 2
    s_waitcnt vmcnt(0)
    s_barrier
    s_cmp_lg_u32 s16, 0
    s_cbranch_scc1 L_nosig_10
    s_mov_b32 s38, 1
    s_atomic_add s38, s[14:15], s48
L_nosig_10:
    s_and_b32 s19, s18, 3
    s_lshl_b32 s20, s17, 2
    s_add_u32 s19, s19, s20
    s_lshr_b32 s20, s18, 2
    s_lshl_b32 s20, s20, 3
    s_and_b32 s26, s16, 3
    s_lshr_b32 s27, s16, 2
    s_lshl_b32 s22, s26, 1
    s_add_u32 s20, s20, s22
    s_lshl_b32 s21, s19, 16
    s_add_u32 s21, s21, s41
    s_and_b32 s24, s26, 1
    s_lshr_b32 s25, s26, 1
    s_lshl_b32 s28, s24, 16
    s_add_u32 s28, s28, 32768
    s_lshl_b32 s29, s24, 21
    s_add_u32 s29, s29, s21
    s_add_u32 s29, s29, 0x200000
    v_and_b32 v20, 11, v0
    v_cmp_eq_u32 vcc, 0, v20
    v_mov_b32 v21, 0x3f803f80
    s_lshl_b32 s30, s26, 10
    s_add_u32 s30, s30, 0
    v_cndmask_b32 v132, 0, v21, vcc
    v_add_u32 v20, s30, v2
    v_mov_b32 v133, v132
    v_mov_b32 v134, v132
    v_mov_b32 v135, v132
    ds_write_b128 v20, v[132:135]
    v_lshrrev_b32 v20, 5, v0
    v_lshlrev_b32 v20, 8, v20
    v_and_b32 v21, 15, v0
    v_lshl_add_u32 v20, v21, 4, v20
    v_and_b32 v21, 16, v0
    v_cmp_eq_u32 vcc, 0, v21
    s_lshl_b32 s30, s27, 15
    s_add_u32 s30, s30, 32768
    v_and_b32 v27, 0x23, v0
    v_bfe_u32 v26, v0, 2, 1
    v_lshl_or_b32 v27, v26, 4, v27
    v_bfe_u32 v26, v0, 3, 2
    v_lshl_or_b32 v27, v26, 2, v27
    v_lshlrev_b32 v27, 4, v27
    v_mov_b32 v26, 0xdddddddd
    v_add_u32 v16, s30, v27
    s_add_u32 s31, s30, 0x10000
    v_mov_b32 v21, s31
    v_mov_b32 v18, 0
    v_cndmask_b32 v21, v18, v21, vcc
    v_add_u32 v17, v20, v21
    v_mov_b32 v21, 98304
    v_cndmask_b32 v21, v18, v21, vcc
    v_add_u32 v19, v20, v21
    v_mov_b32 v21, 2048
    v_cndmask_b32 v18, 0, v21, vcc
    v_mov_b32 v68, 0
    v_mov_b32 v69, 0
    v_mov_b32 v70, 0
    v_mov_b32 v71, 0
    v_mov_b32 v72, 0
    v_mov_b32 v73, 0
    v_mov_b32 v74, 0
    v_mov_b32 v75, 0
    v_mov_b32 v76, 0
    v_mov_b32 v77, 0
    v_mov_b32 v78, 0
    v_mov_b32 v79, 0
    v_mov_b32 v80, 0
    v_mov_b32 v81, 0
    v_mov_b32 v82, 0
    v_mov_b32 v83, 0
    v_mov_b32 v84, 0
    v_mov_b32 v85, 0
    v_mov_b32 v86, 0
    v_mov_b32 v87, 0
    v_mov_b32 v88, 0
    v_mov_b32 v89, 0
    v_mov_b32 v90, 0
    v_mov_b32 v91, 0
    v_mov_b32 v92, 0
    v_mov_b32 v93, 0
    v_mov_b32 v94, 0
    v_mov_b32 v95, 0
    v_mov_b32 v96, 0
    v_mov_b32 v97, 0
    v_mov_b32 v98, 0
    v_mov_b32 v99, 0
    v_mov_b32 v160, 0
    v_mov_b32 v161, 0
    v_mov_b32 v162, 0
    v_mov_b32 v163, 0
    ds_write_b128 v2, v[160:163] offset:13312
    s_mul_i32 s30, s26, 2304
    s_add_u32 s30, s30, 4096
    s_lshl_b32 s31, s26, 12
    s_add_u32 s31, s31, 16384
    s_cmp_eq_u32 s27, 0
    s_cselect_b32 s35, s30, s31
    s_cselect_b32 s36, s31, s30
    v_add_u32 v22, s35, v2
    v_add_u32 v23, s36, v2
    v_add_u32 v24, s35, v1
    v_add_u32 v25, s36, v1
    s_add_u32 s20, s20, s27
    s_lshl_b32 s22, s20, 10
    s_add_u32 s22, s22, s21
    s_xor_b32 s35, s22, 1024
    s_add_u32 s36, s21, 0x200000
    s_lshr_b32 s23, s19, 1
    s_cmp_eq_u32 s40, 0
    s_cselect_b32 s53, 32, 16
    s_cselect_b32 s52, -2, -1
    s_cselect_b32 s32, 1, 2
    s_and_b32 s23, s23, s52
    s_lshl_b32 s23, s23, 8
    s_add_u32 s23, s23, s42
    s_mov_b32 s34, 15
    s_mov_b32 s33, 13
    s_cmp_ge_u32 s2, 176
    s_cbranch_scc1 L_d_14
    s_cmp_ge_u32 s2, 160
    s_cbranch_scc1 L_o_13
    s_cmp_ge_u32 s2, 48
    s_cbranch_scc1 L_gu_12
    s_mov_b32 s80, s66
    s_and_b32 s81, s67, 0xffff
    s_mov_b32 s82, 0x180000
    s_mov_b32 s83, 0x20000
    s_mov_b32 s84, s66
    s_and_b32 s85, s67, 0xffff
    s_mov_b32 s86, 0x180000
    s_mov_b32 s87, 0x20000
    s_sub_u32 s55, s2, 0
    s_and_b32 s79, s55, 3
    s_lshr_b32 s91, s55, 2
    s_mov_b32 s88, 3072
    s_lshl_b32 s89, s91, 8
    s_add_u32 s90, s89, 128
    s_branch L_go_15
L_gu_12:
    s_mov_b32 s80, s72
    s_and_b32 s81, s73, 0xffff
    s_mov_b32 s82, 0x1c0000
    s_mov_b32 s83, 0x20000
    s_mov_b32 s84, s74
    s_and_b32 s85, s75, 0xffff
    s_mov_b32 s86, 0x1c0000
    s_mov_b32 s87, 0x20000
    s_sub_u32 s55, s2, 48
    s_and_b32 s79, s55, 3
    s_lshr_b32 s91, s55, 2
    s_mov_b32 s88, 3584
    s_lshl_b32 s89, s91, 7
    s_add_u32 s90, s89, 0
    s_branch L_go_15
L_o_13:
    s_mov_b32 s80, s68
    s_and_b32 s81, s69, 0xffff
    s_mov_b32 s82, 0x80000
    s_mov_b32 s83, 0x20000
    s_mov_b32 s84, s68
    s_and_b32 s85, s69, 0xffff
    s_mov_b32 s86, 0x80000
    s_mov_b32 s87, 0x20000
    s_sub_u32 s55, s2, 160
    s_and_b32 s91, s55, 3
    s_lshr_b32 s79, s55, 2
    s_mov_b32 s88, 1024
    s_lshl_b32 s89, s91, 8
    s_add_u32 s90, s89, 128
    s_branch L_go_15
L_d_14:
    s_mov_b32 s80, s76
    s_and_b32 s81, s77, 0xffff
    s_mov_b32 s82, 0x1c0000
    s_mov_b32 s83, 0x20000
    s_mov_b32 s84, s76
    s_and_b32 s85, s77, 0xffff
    s_mov_b32 s86, 0x1c0000
    s_mov_b32 s87, 0x20000
    s_sub_u32 s55, s2, 176
    s_and_b32 s91, s55, 3
    s_lshr_b32 s79, s55, 2
    s_mov_b32 s88, 1024
    s_lshl_b32 s89, s91, 8
    s_add_u32 s90, s89, 128
L_go_15:
    s_lshl2_add_u32 s92, s79, s26
    s_lshl_b32 s62, s92, 5
    s_mul_i32 s62, s62, s88
    s_add_u32 s89, s89, s62
    s_add_u32 s90, s90, s62
    s_lshl_b32 s55, s88, 3
    v_lshrrev_b32 v224, 3, v0
    v_mul_lo_u32 v224, v224, s88
    v_and_b32 v225, 7, v0
    v_lshl_add_u32 v224, v225, 4, v224
    s_cmp_lg_u32 s27, 0
    s_cbranch_scc1 L_yparam_16
    s_cmp_lg_u32 s16, 0
    s_cbranch_scc1 L_att_setup_11
    s_mov_b32 s39, 1048576
L_poll_17:
    s_mov_b32 s49, 0
    s_atomic_add s49, s[14:15], s23 glc
    s_sub_u32 s39, s39, 1
    s_waitcnt lgkmcnt(0)
    s_cmp_ge_u32 s49, s53
    s_cbranch_scc1 L_pok_18
    s_sleep 1
    s_cmp_lg_u32 s39, 0
    s_cbranch_scc1 L_poll_17
L_pok_18:
    s_branch L_att_setup_11
L_yparam_16:
    s_mul_i32 s50, s18, 60928
    s_and_b32 s23, s17, 1
    s_mul_i32 s23, s23, 1949696
    s_add_u32 s50, s50, s23
    s_mul_i32 s23, s26, 16384
    s_add_u32 s50, s50, s23
    s_add_u32 s50, s50, 0x300000
    s_lshl2_add_u32 s51, s18, s26
    s_mul_i32 s51, s51, 4096
    s_and_b32 s23, s17, 0
    s_mul_i32 s23, s23, 524288
    s_add_u32 s51, s51, s23
    s_add_u32 s51, s51, 0x200000
    s_lshl2_add_u32 s52, s18, s26
    s_mul_i32 s52, s52, 14336
    s_and_b32 s23, s17, 0
    s_mul_i32 s23, s23, 1835008
    s_add_u32 s52, s52, s23
    s_add_u32 s52, s52, 0x700000
    s_mov_b32 s39, 1048576
    s_mov_b32 s33, 6
    s_mov_b32 s34, 15
    s_cmp_lg_u32 s40, 0
    s_cbranch_scc1 L_att_setup_11
    s_mov_b32 s33, 1
    s_mov_b32 s34, 12
L_att_setup_11:
    s_waitcnt lgkmcnt(0)
    s_barrier
    s_cmp_eq_u32 s27, 0
    s_cbranch_scc1 L_older_19
    s_mul_i32 s24, s25, 2048
    s_add_u32 s30, s28, s24
    s_mov_b32 m0, s30
    s_add_u32 s31, s29, s24
    buffer_load_dwordx4 v2, s[4:7], s31 offen offset:0 sc1 lds
    buffer_load_dwordx4 v2, s[4:7], s31 offen offset:1024 sc1 lds
    s_mul_i32 s24, s25, 6144
    s_add_u32 s24, s24, 4096
    s_add_u32 s30, s28, s24
    s_mov_b32 m0, s30
    s_add_u32 s31, s29, s24
    buffer_load_dwordx4 v2, s[4:7], s31 offen offset:0 sc1 lds
    buffer_load_dwordx4 v2, s[4:7], s31 offen offset:1024 sc1 lds
    buffer_load_dwordx4 v2, s[4:7], s31 offen offset:2048 sc1 lds
    buffer_load_dwordx4 v2, s[4:7], s31 offen offset:3072 sc1 lds
    s_add_u32 s24, s24, 4096
    s_add_u32 s30, s28, s24
    s_mov_b32 m0, s30
    s_add_u32 s31, s29, s24
    buffer_load_dwordx4 v2, s[4:7], s31 offen offset:0 sc1 lds
    buffer_load_dwordx4 v2, s[4:7], s31 offen offset:1024 sc1 lds
    s_waitcnt vmcnt(6)
    s_barrier
    buffer_load_dwordx4 v[144:147], v27, s[4:7], s36 offen sc1
    buffer_load_dwordx4 v[28:31], v2, s[4:7], s35 offen sc1
    buffer_load_dwordx4 v[32:35], v2, s[4:7], s22 offen sc1
    s_mul_i32 s24, s25, 8192
    s_add_u32 s24, s24, 16384
    s_add_u32 s30, s28, s24
    s_mov_b32 m0, s30
    s_add_u32 s31, s29, s24
    buffer_load_dwordx4 v2, s[4:7], s31 offen offset:0 sc1 lds
    buffer_load_dwordx4 v2, s[4:7], s31 offen offset:1024 sc1 lds
    buffer_load_dwordx4 v2, s[4:7], s31 offen offset:2048 sc1 lds
    buffer_load_dwordx4 v2, s[4:7], s31 offen offset:3072 sc1 lds
    s_add_u32 s24, s24, 4096
    s_add_u32 s30, s28, s24
    s_mov_b32 m0, s30
    s_add_u32 s31, s29, s24
    buffer_load_dwordx4 v2, s[4:7], s31 offen offset:0 sc1 lds
    buffer_load_dwordx4 v2, s[4:7], s31 offen offset:1024 sc1 lds
    buffer_load_dwordx4 v2, s[4:7], s31 offen offset:2048 sc1 lds
    buffer_load_dwordx4 v2, s[4:7], s31 offen offset:3072 sc1 lds
    s_waitcnt vmcnt(11)
    s_barrier
    s_mul_i32 s24, s25, 16384
    s_add_u32 s24, s24, 32768
    s_add_u32 s30, s28, s24
    s_mov_b32 m0, s30
    s_add_u32 s31, s29, s24
    buffer_load_dwordx4 v2, s[4:7], s31 offen offset:0 sc1 lds
    buffer_load_dwordx4 v2, s[4:7], s31 offen offset:1024 sc1 lds
    buffer_load_dwordx4 v2, s[4:7], s31 offen offset:2048 sc1 lds
    buffer_load_dwordx4 v2, s[4:7], s31 offen offset:3072 sc1 lds
    s_add_u32 s24, s24, 4096
    s_add_u32 s30, s28, s24
    s_mov_b32 m0, s30
    s_add_u32 s31, s29, s24
    buffer_load_dwordx4 v2, s[4:7], s31 offen offset:0 sc1 lds
    buffer_load_dwordx4 v2, s[4:7], s31 offen offset:1024 sc1 lds
    buffer_load_dwordx4 v2, s[4:7], s31 offen offset:2048 sc1 lds
    buffer_load_dwordx4 v2, s[4:7], s31 offen offset:3072 sc1 lds
    s_add_u32 s24, s24, 4096
    s_add_u32 s30, s28, s24
    s_mov_b32 m0, s30
    s_add_u32 s31, s29, s24
    buffer_load_dwordx4 v2, s[4:7], s31 offen offset:0 sc1 lds
    buffer_load_dwordx4 v2, s[4:7], s31 offen offset:1024 sc1 lds
    buffer_load_dwordx4 v2, s[4:7], s31 offen offset:2048 sc1 lds
    buffer_load_dwordx4 v2, s[4:7], s31 offen offset:3072 sc1 lds
    s_add_u32 s24, s24, 4096
    s_add_u32 s30, s28, s24
    s_mov_b32 m0, s30
    s_add_u32 s31, s29, s24
    buffer_load_dwordx4 v2, s[4:7], s31 offen offset:0 sc1 lds
    buffer_load_dwordx4 v2, s[4:7], s31 offen offset:1024 sc1 lds
    buffer_load_dwordx4 v2, s[4:7], s31 offen offset:2048 sc1 lds
    buffer_load_dwordx4 v2, s[4:7], s31 offen offset:3072 sc1 lds
    s_waitcnt vmcnt(24)
    v_mfma_f32_32x32x16_bf16 v[100:115], v[144:147], v[28:31], 0
    v_mfma_f32_32x32x16_bf16 v[116:131], v[144:147], v[32:35], 0
    s_nop 11
    v_max3_f32 v20, v100, v101, v102
    v_max3_f32 v132, v108, v109, v110
    v_max3_f32 v21, v116, v117, v118
    v_max3_f32 v133, v124, v125, v126
    v_max3_f32 v20, v20, v103, v104
    v_max3_f32 v132, v132, v111, v112
    v_max3_f32 v21, v21, v119, v120
    v_max3_f32 v133, v133, v127, v128
    v_max3_f32 v20, v20, v105, v106
    v_max3_f32 v132, v132, v113, v114
    v_max3_f32 v21, v21, v121, v122
    v_max3_f32 v133, v133, v129, v130
    v_max3_f32 v20, v20, v107, v115
    v_max3_f32 v21, v21, v123, v131
    v_max_f32 v20, v20, v132
    v_max_f32 v21, v21, v133
    v_mov_b32 v132, v20
    v_mov_b32 v133, v21
    s_nop 0
    v_permlane32_swap_b32 v20, v132
    v_permlane32_swap_b32 v21, v133
    v_min_f32 v36, -v20, -v132
    v_min_f32 v52, -v21, -v133
    v_mov_b32 v37, v36
    v_mov_b32 v53, v52
    v_pk_mov_b32 v[38:39], v[36:37], v[36:37]
    v_pk_mov_b32 v[40:41], v[36:37], v[36:37]
    v_pk_mov_b32 v[42:43], v[36:37], v[36:37]
    v_pk_mov_b32 v[44:45], v[36:37], v[36:37]
    v_pk_mov_b32 v[46:47], v[36:37], v[36:37]
    v_pk_mov_b32 v[48:49], v[36:37], v[36:37]
    v_pk_mov_b32 v[50:51], v[36:37], v[36:37]
    v_pk_mov_b32 v[54:55], v[52:53], v[52:53]
    v_pk_mov_b32 v[56:57], v[52:53], v[52:53]
    v_pk_mov_b32 v[58:59], v[52:53], v[52:53]
    v_pk_mov_b32 v[60:61], v[52:53], v[52:53]
    v_pk_mov_b32 v[62:63], v[52:53], v[52:53]
    v_pk_mov_b32 v[64:65], v[52:53], v[52:53]
    v_pk_mov_b32 v[66:67], v[52:53], v[52:53]
    s_waitcnt vmcnt(0)
    s_barrier
    s_setprio 1
    ds_read_b128 v[140:143], v16
    ds_read_b128 v[148:151], v17
    ds_read_b128 v[152:155], v17 offset:512
    s_cmp_lg_u32 s40, 0
    s_cbranch_scc1 L_noraw_21
    buffer_load_dwordx4 v[176:179], v224, s[80:83], s89 offen
    s_add_u32 s89, s89, s55
    buffer_load_dwordx4 v[192:195], v224, s[84:87], s90 offen
    s_add_u32 s90, s90, s55
    buffer_load_dwordx4 v[180:183], v224, s[80:83], s89 offen
    s_add_u32 s89, s89, s55
    buffer_load_dwordx4 v[196:199], v224, s[84:87], s90 offen
    s_add_u32 s90, s90, s55
    buffer_load_dwordx4 v[184:187], v224, s[80:83], s89 offen
    s_add_u32 s89, s89, s55
    buffer_load_dwordx4 v[200:203], v224, s[84:87], s90 offen
    s_add_u32 s90, s90, s55
    buffer_load_dwordx4 v[188:191], v224, s[80:83], s89 offen
    s_add_u32 s89, s89, s55
    buffer_load_dwordx4 v[204:207], v224, s[84:87], s90 offen
    s_add_u32 s90, s90, s55
L_noraw_21:
    s_waitcnt lgkmcnt(0)
    v_mfma_f32_32x32x16_bf16 v[100:115], v[140:143], v[28:31], v[36:51]
    s_nop 10
    s_branch L_join_20
L_older_19:
    buffer_load_dwordx4 v[144:147], v27, s[4:7], s36 offen sc1
    buffer_load_dwordx4 v[28:31], v2, s[4:7], s35 offen sc1
    buffer_load_dwordx4 v[32:35], v2, s[4:7], s22 offen sc1
    s_waitcnt vmcnt(0)
    v_mfma_f32_32x32x16_bf16 v[100:115], v[144:147], v[28:31], 0
    v_mfma_f32_32x32x16_bf16 v[116:131], v[144:147], v[32:35], 0
    s_nop 11
    v_max3_f32 v20, v100, v101, v102
    v_max3_f32 v132, v108, v109, v110
    v_max3_f32 v21, v116, v117, v118
    v_max3_f32 v133, v124, v125, v126
    v_max3_f32 v20, v20, v103, v104
    v_max3_f32 v132, v132, v111, v112
    v_max3_f32 v21, v21, v119, v120
    v_max3_f32 v133, v133, v127, v128
    v_max3_f32 v20, v20, v105, v106
    v_max3_f32 v132, v132, v113, v114
    v_max3_f32 v21, v21, v121, v122
    v_max3_f32 v133, v133, v129, v130
    v_max3_f32 v20, v20, v107, v115
    v_max3_f32 v21, v21, v123, v131
    v_max_f32 v20, v20, v132
    v_max_f32 v21, v21, v133
    v_mov_b32 v132, v20
    v_mov_b32 v133, v21
    s_nop 0
    v_permlane32_swap_b32 v20, v132
    v_permlane32_swap_b32 v21, v133
    v_min_f32 v36, -v20, -v132
    v_min_f32 v52, -v21, -v133
    v_mov_b32 v37, v36
    v_mov_b32 v53, v52
    v_pk_mov_b32 v[38:39], v[36:37], v[36:37]
    v_pk_mov_b32 v[40:41], v[36:37], v[36:37]
    v_pk_mov_b32 v[42:43], v[36:37], v[36:37]
    v_pk_mov_b32 v[44:45], v[36:37], v[36:37]
    v_pk_mov_b32 v[46:47], v[36:37], v[36:37]
    v_pk_mov_b32 v[48:49], v[36:37], v[36:37]
    v_pk_mov_b32 v[50:51], v[36:37], v[36:37]
    v_pk_mov_b32 v[54:55], v[52:53], v[52:53]
    v_pk_mov_b32 v[56:57], v[52:53], v[52:53]
    v_pk_mov_b32 v[58:59], v[52:53], v[52:53]
    v_pk_mov_b32 v[60:61], v[52:53], v[52:53]
    v_pk_mov_b32 v[62:63], v[52:53], v[52:53]
    v_pk_mov_b32 v[64:65], v[52:53], v[52:53]
    v_pk_mov_b32 v[66:67], v[52:53], v[52:53]
    v_mfma_f32_32x32x16_bf16 v[100:115], v[144:147], v[28:31], v[36:51]
    s_barrier
    ds_read_b128 v[148:151], v17
    ds_read_b128 v[152:155], v17 offset:512
    v_pk_mov_b32 v[140:141], v[144:145], v[144:145] op_sel:[0,1]
    v_pk_mov_b32 v[142:143], v[146:147], v[146:147] op_sel:[0,1]
    s_waitcnt lgkmcnt(0)
    s_nop 5
L_join_20:
    s_mov_b32 s31, 16
L_attn_22:
    v_exp_f32 v100, v100
    v_exp_f32 v101, v101
    v_smfmac_f32_32x32x32_bf16 v[84:99], v[160:163], v[124:131], v26
    ds_read_b128 v[144:147], v16 offset:1024
    v_exp_f32 v102, v102
    v_exp_f32 v103, v103
    v_exp_f32 v104, v104
    v_mfma_f32_32x32x16_bf16 v[116:131], v[140:143], v[32:35], v[52:67]
    ds_read_b128 v[156:159], v17 offset:1024
    v_exp_f32 v105, v105
    v_exp_f32 v106, v106
    v_exp_f32 v107, v107
    v_exp_f32 v108, v108
    v_exp_f32 v109, v109
    v_exp_f32 v110, v110
    v_smfmac_f32_32x32x32_bf16 v[68:83], v[148:151], v[100:107], v26
    ds_read_b128 v[160:163], v17 offset:1536
    v_exp_f32 v111, v111
    v_exp_f32 v112, v112
    v_exp_f32 v113, v113
    v_exp_f32 v114, v114
    v_exp_f32 v115, v115
    v_exp_f32 v116, v116
    v_exp_f32 v117, v117
    v_smfmac_f32_32x32x32_bf16 v[68:83], v[152:155], v[108:115], v26
    s_waitcnt lgkmcnt(0)
    v_exp_f32 v118, v118
    v_exp_f32 v119, v119
    v_exp_f32 v120, v120
    v_mfma_f32_32x32x16_bf16 v[100:115], v[144:147], v[28:31], v[36:51]
    v_exp_f32 v121, v121
    v_exp_f32 v122, v122
    v_exp_f32 v123, v123
    v_exp_f32 v124, v124
    v_exp_f32 v125, v125
    v_exp_f32 v126, v126
    v_smfmac_f32_32x32x32_bf16 v[84:99], v[148:151], v[116:123], v26
    v_exp_f32 v127, v127
    v_exp_f32 v128, v128
    v_exp_f32 v129, v129
    v_exp_f32 v130, v130
    v_exp_f32 v131, v131
    v_exp_f32 v100, v100
    v_exp_f32 v101, v101
    v_smfmac_f32_32x32x32_bf16 v[84:99], v[152:155], v[124:131], v26
    ds_read_b128 v[140:143], v16 offset:2048
    v_exp_f32 v102, v102
    v_exp_f32 v103, v103
    v_exp_f32 v104, v104
    v_mfma_f32_32x32x16_bf16 v[116:131], v[144:147], v[32:35], v[52:67]
    ds_read_b128 v[148:151], v17 offset:2048
    v_exp_f32 v105, v105
    v_exp_f32 v106, v106
    v_exp_f32 v107, v107
    v_exp_f32 v108, v108
    v_exp_f32 v109, v109
    v_exp_f32 v110, v110
    v_smfmac_f32_32x32x32_bf16 v[68:83], v[156:159], v[100:107], v26
    ds_read_b128 v[152:155], v17 offset:2560
    v_exp_f32 v111, v111
    v_exp_f32 v112, v112
    v_exp_f32 v113, v113
    v_exp_f32 v114, v114
    v_exp_f32 v115, v115
    v_exp_f32 v116, v116
    v_exp_f32 v117, v117
    v_smfmac_f32_32x32x32_bf16 v[68:83], v[160:163], v[108:115], v26
    s_waitcnt lgkmcnt(0)
    v_exp_f32 v118, v118
    v_exp_f32 v119, v119
    v_exp_f32 v120, v120
    v_mfma_f32_32x32x16_bf16 v[100:115], v[140:143], v[28:31], v[36:51]
    s_cmp_lg_u32 s31, s32
    s_cbranch_scc1 L_keep_27
    s_setprio 0
L_keep_27:
    v_exp_f32 v121, v121
    v_exp_f32 v122, v122
    v_exp_f32 v123, v123
    v_exp_f32 v124, v124
    v_exp_f32 v125, v125
    v_exp_f32 v126, v126
    v_smfmac_f32_32x32x32_bf16 v[84:99], v[156:159], v[116:123], v26
    s_sub_u32 s31, s31, 1
    s_cmp_lg_u32 s31, s34
    v_exp_f32 v127, v127
    v_exp_f32 v128, v128
    v_exp_f32 v129, v129
    v_add_u32 v16, 2048, v16
    v_add_u32 v17, v18, v17
    v_exp_f32 v130, v130
    v_exp_f32 v131, v131
    s_cbranch_scc1 L_attn_22
    s_cmp_lg_u32 s31, 0
    s_cbranch_scc1 L_hook_23
L_exitc_26:
    s_cmp_lg_u32 s33, 0
    s_cbranch_scc1 L_hookp_25
    s_setprio 0
    v_smfmac_f32_32x32x32_bf16 v[84:99], v[160:163], v[124:131], v26
    ds_write_b128 v22, v[68:71]
    ds_write_b128 v22, v[72:75] offset:1024
    ds_write_b32 v24, v76 offset:2048
    s_lshl_b32 s22, s20, 15
    s_lshl_b32 s23, s19, 10
    s_add_u32 s22, s22, s23
    s_add_u32 s22, s22, s41
    s_add_u32 s22, s22, 0x600000
    s_lshl_b32 s48, s20, 8
    s_add_u32 s48, s48, s42
    s_add_u32 s48, s48, 0x8000
    s_waitcnt vmcnt(0) lgkmcnt(0)
    s_barrier
    ds_read_b32 v108, v25 offset:2048
    ds_read_b128 v[100:103], v23
    ds_read_b128 v[104:107], v23 offset:1024
    s_waitcnt lgkmcnt(2)
    v_add_f32 v92, v92, v108
    v_rcp_f32 v20, v92
    s_waitcnt lgkmcnt(1)
    v_pk_add_f32 v[84:85], v[84:85], v[100:101]
    v_pk_add_f32 v[86:87], v[86:87], v[102:103]
    s_waitcnt lgkmcnt(0)
    v_pk_add_f32 v[88:89], v[88:89], v[104:105]
    v_pk_add_f32 v[90:91], v[90:91], v[106:107]
    v_pk_add_f32 v[100:101], v[84:85], v[86:87]
    v_pk_add_f32 v[102:103], v[88:89], v[90:91]
    v_pk_add_f32 v[100:101], v[100:101], v[102:103]
    v_add_f32 v21, v100, v101
    v_fma_f32 v21, 0, v21, v92
    v_cmp_ngt_f32 vcc, 0x5f800000, v21
    s_nop 0
    s_cbranch_vccnz L_fallback_29
L_fin_28:
    v_pk_mul_f32 v[84:85], v[84:85], v[20:21] op_sel_hi:[1,0]
    v_pk_mul_f32 v[86:87], v[86:87], v[20:21] op_sel_hi:[1,0]
    v_pk_mul_f32 v[88:89], v[88:89], v[20:21] op_sel_hi:[1,0]
    v_pk_mul_f32 v[90:91], v[90:91], v[20:21] op_sel_hi:[1,0]
    v_cvt_pk_bf16_f32 v132, v84, v85
    v_cvt_pk_bf16_f32 v133, v86, v87
    v_cvt_pk_bf16_f32 v134, v88, v89
    v_cvt_pk_bf16_f32 v135, v90, v91
    buffer_store_dwordx4 v[132:135], v2, s[4:7], s22 offen sc1
    s_barrier
    s_branch L_att_end_30
L_back_24:
    s_cmp_lg_u32 s31, 0
    s_cbranch_scc1 L_attn_22
    s_sub_u32 s39, s39, 1
    s_cmp_eq_u32 s39, 0
    s_cselect_b32 s33, 0, s33
    s_branch L_exitc_26
L_hook_23:
    s_cmp_eq_u32 s27, 0
    s_cbranch_scc0 L_hookp_25
    s_barrier
    s_mov_b32 s34, s33
    s_mov_b32 s33, 0
    s_add_u32 s23, s34, s40
    s_cmp_lg_u32 s23, 0
    s_cbranch_scc1 L_back_24
    v_and_b32 v176, 15, v0
    v_lshlrev_b32 v176, 10, v176
    v_and_b32 v177, 48, v0
    v_add_u32 v176, v176, v177
    s_and_b32 s23, s16, 1
    s_add_u32 s23, s23, s43
    s_lshl_b32 s23, s23, 15
    s_lshl_b32 s24, s44, 1
    s_lshr_b32 s25, s16, 1
    s_add_u32 s24, s24, s25
    s_lshl_b32 s24, s24, 6
    s_add_u32 s23, s23, s24
    buffer_load_dwordx4 v[4:7], v176, s[8:11], s23 offen
    s_add_u32 s24, s23, 16384
    buffer_load_dwordx4 v[8:11], v176, s[8:11], s24 offen
    s_branch L_back_24
L_hookp_25:
    s_cmp_eq_u32 s33, 1
    s_cbranch_scc1 L_hs1_32
    s_cmp_eq_u32 s33, 2
    s_cbranch_scc1 L_hs2_33
    s_cmp_eq_u32 s33, 3
    s_cbranch_scc1 L_hs3_34
    s_cmp_eq_u32 s33, 4
    s_cbranch_scc1 L_hs4_35
    s_cmp_eq_u32 s33, 5
    s_cbranch_scc1 L_hs5_36
    s_cmp_eq_u32 s33, 6
    s_cbranch_scc1 L_hs6_37
    s_mul_i32 s23, s44, 229376
    s_lshl_b32 s62, s26, 12
    s_add_u32 s23, s23, s62
    s_add_u32 s23, s23, 0x724000
    buffer_load_dwordx4 v[176:179], v2, s[4:7], s23 offen offset:0 sc1
    buffer_load_dwordx4 v[180:183], v2, s[4:7], s23 offen offset:1024 sc1
    buffer_load_dwordx4 v[184:187], v2, s[4:7], s23 offen offset:2048 sc1
    buffer_load_dwordx4 v[188:191], v2, s[4:7], s23 offen offset:3072 sc1
    s_add_u32 s23, s23, 16384
    buffer_load_dwordx4 v[192:195], v2, s[4:7], s23 offen offset:0 sc1
    buffer_load_dwordx4 v[196:199], v2, s[4:7], s23 offen offset:1024 sc1
    buffer_load_dwordx4 v[200:203], v2, s[4:7], s23 offen offset:2048 sc1
    buffer_load_dwordx4 v[204:207], v2, s[4:7], s23 offen offset:3072 sc1
    s_add_u32 s23, s23, 16384
    buffer_load_dwordx4 v[208:211], v2, s[4:7], s23 offen offset:0 sc1
    buffer_load_dwordx4 v[212:215], v2, s[4:7], s23 offen offset:1024 sc1
    buffer_load_dwordx4 v[216:219], v2, s[4:7], s23 offen offset:2048 sc1
    buffer_load_dwordx4 v[220:223], v2, s[4:7], s23 offen offset:3072 sc1
    s_add_u32 s23, s23, 16384
    buffer_load_dwordx4 v[224:227], v2, s[4:7], s23 offen offset:0 sc1
    buffer_load_dwordx4 v[228:231], v2, s[4:7], s23 offen offset:1024 sc1
    buffer_load_dwordx4 v[232:235], v2, s[4:7], s23 offen offset:2048 sc1
    buffer_load_dwordx4 v[236:239], v2, s[4:7], s23 offen offset:3072 sc1
    s_add_u32 s23, s23, 16384
    buffer_load_dwordx4 v[240:243], v2, s[4:7], s23 offen offset:0 sc1
    buffer_load_dwordx4 v[244:247], v2, s[4:7], s23 offen offset:1024 sc1
    buffer_load_dwordx4 v[248:251], v2, s[4:7], s23 offen offset:2048 sc1
    buffer_load_dwordx4 v[252:255], v2, s[4:7], s23 offen offset:3072 sc1
    s_add_u32 s23, s23, 16384
    s_mov_b32 s33, 0
    s_mov_b32 s34, 0
    s_branch L_back_24
L_hs1_32:
    s_cmp_ge_u32 s2, 232
    s_cbranch_scc1 L_nostore_39
    v_mov_b32 v236, v2
    s_cmp_ge_u32 s2, 176
    s_cbranch_scc1 L_d_42
    s_cmp_ge_u32 s2, 160
    s_cbranch_scc1 L_o_41
    s_cmp_ge_u32 s2, 48
    s_cbranch_scc1 L_gu_40
    s_and_b32 s62, s91, 3
    s_mul_i32 s96, s62, 417792
    s_lshr_b32 s62, s91, 2
    s_lshr_b32 s78, s62, 1
    s_lshl_b32 s62, s62, 11
    s_add_u32 s96, s96, s62
    s_add_u32 s97, s96, 1024
    s_add_u32 s100, s96, 104448
    s_add_u32 s101, s96, 105472
    s_mov_b32 s93, 208896
    s_mov_b32 s80, 6144
    s_mov_b32 s81, 6144
    s_mov_b32 s82, 6144
    s_mov_b32 s83, 6144
    s_mov_b32 s63, 1
    s_branch L_go_43
L_gu_40:
    s_lshl_b32 s55, s91, 2
    s_mul_i32 s62, s55, 9363
    s_lshr_b32 s62, s62, 16
    s_mul_i32 s96, s62, 243712
    s_mul_i32 s62, s62, 7
    s_sub_u32 s62, s55, s62
    s_mov_b32 s78, 0
    s_mov_b32 s80, 4
    s_cmp_ge_u32 s62, 4
    s_cselect_b32 s78, 4, s78
    s_cselect_b32 s80, 2, s80
    s_cmp_ge_u32 s62, 6
    s_cselect_b32 s78, 6, s78
    s_cselect_b32 s80, 1, s80
    s_lshl_b32 s80, s80, 11
    s_lshl4_add_u32 s62, s78, s62
    s_lshl_b32 s62, s62, 11
    s_add_u32 s96, s96, s62
    s_add_u32 s96, s96, 0x300000
    s_add_u32 s55, s55, 1
    s_mul_i32 s62, s55, 9363
    s_lshr_b32 s62, s62, 16
    s_mul_i32 s97, s62, 243712
    s_mul_i32 s62, s62, 7
    s_sub_u32 s62, s55, s62
    s_mov_b32 s78, 0
    s_mov_b32 s81, 4
    s_cmp_ge_u32 s62, 4
    s_cselect_b32 s78, 4, s78
    s_cselect_b32 s81, 2, s81
    s_cmp_ge_u32 s62, 6
    s_cselect_b32 s78, 6, s78
    s_cselect_b32 s81, 1, s81
    s_lshl_b32 s81, s81, 11
    s_lshl4_add_u32 s62, s78, s62
    s_lshl_b32 s62, s62, 11
    s_add_u32 s97, s97, s62
    s_add_u32 s97, s97, 0x300000
    s_add_u32 s55, s55, 1
    s_mul_i32 s62, s55, 9363
    s_lshr_b32 s62, s62, 16
    s_mul_i32 s100, s62, 243712
    s_mul_i32 s62, s62, 7
    s_sub_u32 s62, s55, s62
    s_mov_b32 s78, 0
    s_mov_b32 s82, 4
    s_cmp_ge_u32 s62, 4
    s_cselect_b32 s78, 4, s78
    s_cselect_b32 s82, 2, s82
    s_cmp_ge_u32 s62, 6
    s_cselect_b32 s78, 6, s78
    s_cselect_b32 s82, 1, s82
    s_lshl_b32 s82, s82, 11
    s_lshl4_add_u32 s62, s78, s62
    s_lshl_b32 s62, s62, 11
    s_add_u32 s100, s100, s62
    s_add_u32 s100, s100, 0x300000
    s_add_u32 s55, s55, 1
    s_mul_i32 s62, s55, 9363
    s_lshr_b32 s62, s62, 16
    s_mul_i32 s101, s62, 243712
    s_mul_i32 s62, s62, 7
    s_sub_u32 s62, s55, s62
    s_mov_b32 s78, 0
    s_mov_b32 s83, 4
    s_cmp_ge_u32 s62, 4
    s_cselect_b32 s78, 4, s78
    s_cselect_b32 s83, 2, s83
    s_cmp_ge_u32 s62, 6
    s_cselect_b32 s78, 6, s78
    s_cselect_b32 s83, 1, s83
    s_lshl_b32 s83, s83, 11
    s_lshl4_add_u32 s62, s78, s62
    s_lshl_b32 s62, s62, 11
    s_add_u32 s101, s101, s62
    s_add_u32 s101, s101, 0x300000
    s_add_u32 s55, s55, 1
    s_mov_b32 s93, 1024
    s_mov_b32 s63, 1
    s_mov_b32 s78, 1
    s_branch L_go_43
L_o_41:
    s_lshl_b32 s96, s91, 17
    s_add_u32 s96, s96, 0x200000
    s_add_u32 s97, s96, 1024
    s_add_u32 s100, s96, 2048
    s_add_u32 s101, s96, 3072
    s_mov_b32 s93, 65536
    s_mov_b32 s80, 4096
    s_mov_b32 s81, 4096
    s_mov_b32 s82, 4096
    s_mov_b32 s83, 4096
    s_mov_b32 s63, 0
    s_mov_b32 s78, 0
    s_branch L_go_43
L_d_42:
    s_mul_i32 s96, s91, 458752
    s_add_u32 s96, s96, 0x700000
    s_add_u32 s97, s96, 1024
    s_add_u32 s100, s96, 2048
    s_add_u32 s101, s96, 3072
    s_mov_b32 s93, 229376
    s_mov_b32 s80, 0
    s_mov_b32 s81, 0
    s_mov_b32 s82, 0
    s_mov_b32 s83, 0
    s_mov_b32 s63, 0
    s_lshl_b32 s62, s92, 1
    s_add_u32 s62, s62, 0
    s_mul_i32 s54, s62, 9363
    s_lshr_b32 s54, s54, 16
    s_mul_i32 s55, s54, 7
    s_sub_u32 s55, s62, s55
    s_mov_b32 s78, 0
    s_mov_b32 s49, 4
    s_cmp_ge_u32 s55, 4
    s_cselect_b32 s78, 4, s78
    s_cselect_b32 s49, 2, s49
    s_cmp_ge_u32 s55, 6
    s_cselect_b32 s78, 6, s78
    s_cselect_b32 s49, 1, s49
    s_mul_i32 s54, s54, s49
    s_mul_i32 s78, s78, 15
    s_add_u32 s54, s54, s78
    s_add_u32 s54, s54, s55
    s_lshr_b32 s55, s54, 1
    s_lshl_b32 s55, s55, 12
    s_and_b32 s54, s54, 1
    s_lshl_b32 s54, s54, 9
    s_add_u32 s84, s54, s55
    s_lshl_b32 s62, s92, 1
    s_add_u32 s62, s62, 1
    s_mul_i32 s54, s62, 9363
    s_lshr_b32 s54, s54, 16
    s_mul_i32 s55, s54, 7
    s_sub_u32 s55, s62, s55
    s_mov_b32 s78, 0
    s_mov_b32 s49, 4
    s_cmp_ge_u32 s55, 4
    s_cselect_b32 s78, 4, s78
    s_cselect_b32 s49, 2, s49
    s_cmp_ge_u32 s55, 6
    s_cselect_b32 s78, 6, s78
    s_cselect_b32 s49, 1, s49
    s_mul_i32 s54, s54, s49
    s_mul_i32 s78, s78, 15
    s_add_u32 s54, s54, s78
    s_add_u32 s54, s54, s55
    s_lshr_b32 s55, s54, 1
    s_lshl_b32 s55, s55, 12
    s_and_b32 s54, s54, 1
    s_lshl_b32 s54, s54, 9
    s_add_u32 s85, s54, s55
    v_cmp_gt_u32 vcc, 32, v0
    v_mov_b32 v228, s84
    v_mov_b32 v229, s85
    v_cndmask_b32 v228, v229, v228, vcc
    v_and_b32 v236, 0x1ff, v2
    v_add_u32 v236, v236, v228
    s_mov_b32 s78, 0
L_go_43:
    s_lshl_b32 s62, s26, 12
    s_add_u32 s62, s62, 16384
    v_add_u32 v224, s62, v2
    v_and_b32 v228, 1, v0
    v_bfe_u32 v229, v0, 1, 1
    v_lshl_add_u32 v228, v228, 1, v229
    v_and_b32 v229, 3, v0
    v_lshlrev_b32 v229, 1, v229
    s_cmp_eq_u32 s78, 0
    s_cselect_b64 vcc, -1, 0
    s_cselect_b32 s55, 8, 32
    v_lshrrev_b32 v225, 4, v0
    v_cndmask_b32 v228, v228, v229, vcc
    v_bfe_u32 v229, v0, 2, 2
    v_lshl_add_u32 v225, v225, 3, v229
    v_lshlrev_b32 v225, 7, v225
    v_lshl_add_u32 v225, v228, 3, v225
    v_add_u32 v225, s62, v225
    v_add_u32 v226, s55, v225
    s_mov_b32 s49, 0x3f803f80
    s_waitcnt vmcnt(0)
    ds_write_b128 v224, v[176:179] offset:0
    ds_write_b128 v224, v[180:183] offset:1024
    ds_write_b128 v224, v[184:187] offset:2048
    ds_write_b128 v224, v[188:191] offset:3072
    ds_read_b64_tr_b16 v[208:209], v225 offset:0
    ds_read_b64_tr_b16 v[210:211], v225 offset:512
    ds_read_b64_tr_b16 v[212:213], v226 offset:0
    ds_read_b64_tr_b16 v[214:215], v226 offset:512
    ds_read_b64_tr_b16 v[216:217], v225 offset:64
    ds_read_b64_tr_b16 v[218:219], v225 offset:576
    ds_read_b64_tr_b16 v[220:221], v226 offset:64
    ds_read_b64_tr_b16 v[222:223], v226 offset:576
    s_waitcnt lgkmcnt(0)
    s_mul_i32 s62, s92, s80
    s_add_u32 s62, s62, s96
    buffer_store_dwordx4 v[208:211], v236, s[4:7], s62 offen sc1
    s_mul_i32 s62, s92, s81
    s_add_u32 s62, s62, s97
    buffer_store_dwordx4 v[212:215], v236, s[4:7], s62 offen sc1
    s_mul_i32 s62, s92, s82
    s_add_u32 s62, s62, s100
    buffer_store_dwordx4 v[216:219], v236, s[4:7], s62 offen sc1
    s_mul_i32 s62, s92, s83
    s_add_u32 s62, s62, s101
    buffer_store_dwordx4 v[220:223], v236, s[4:7], s62 offen sc1
    ds_write_b128 v224, v[192:195] offset:0
    ds_write_b128 v224, v[196:199] offset:1024
    ds_write_b128 v224, v[200:203] offset:2048
    ds_write_b128 v224, v[204:207] offset:3072
    ds_read_b64_tr_b16 v[176:177], v225 offset:0
    ds_read_b64_tr_b16 v[178:179], v225 offset:512
    ds_read_b64_tr_b16 v[180:181], v226 offset:0
    ds_read_b64_tr_b16 v[182:183], v226 offset:512
    ds_read_b64_tr_b16 v[184:185], v225 offset:64
    ds_read_b64_tr_b16 v[186:187], v225 offset:576
    ds_read_b64_tr_b16 v[188:189], v226 offset:64
    ds_read_b64_tr_b16 v[190:191], v226 offset:576
    s_waitcnt lgkmcnt(0)
    s_mul_i32 s62, s92, s80
    s_add_u32 s62, s62, s96
    s_add_u32 s62, s62, s93
    buffer_store_dwordx4 v[176:179], v236, s[4:7], s62 offen sc1
    s_mul_i32 s62, s92, s81
    s_add_u32 s62, s62, s97
    s_add_u32 s62, s62, s93
    buffer_store_dwordx4 v[180:183], v236, s[4:7], s62 offen sc1
    s_mul_i32 s62, s92, s82
    s_add_u32 s62, s62, s100
    s_add_u32 s62, s62, s93
    buffer_store_dwordx4 v[184:187], v236, s[4:7], s62 offen sc1
    s_mul_i32 s62, s92, s83
    s_add_u32 s62, s62, s101
    s_add_u32 s62, s62, s93
    buffer_store_dwordx4 v[188:191], v236, s[4:7], s62 offen sc1
    s_cmp_eq_u32 s63, 0
    s_cbranch_scc1 L_nostore_39
    v_dot2_f32_bf16 v228, v208, s49, 0
    v_dot2_f32_bf16 v229, v212, s49, 0
    v_dot2_f32_bf16 v230, v216, s49, 0
    v_dot2_f32_bf16 v231, v220, s49, 0
    v_dot2_f32_bf16 v232, v176, s49, 0
    v_dot2_f32_bf16 v233, v180, s49, 0
    v_dot2_f32_bf16 v234, v184, s49, 0
    v_dot2_f32_bf16 v235, v188, s49, 0
    v_dot2_f32_bf16 v228, v209, s49, v228
    v_dot2_f32_bf16 v229, v213, s49, v229
    v_dot2_f32_bf16 v230, v217, s49, v230
    v_dot2_f32_bf16 v231, v221, s49, v231
    v_dot2_f32_bf16 v232, v177, s49, v232
    v_dot2_f32_bf16 v233, v181, s49, v233
    v_dot2_f32_bf16 v234, v185, s49, v234
    v_dot2_f32_bf16 v235, v189, s49, v235
    v_dot2_f32_bf16 v228, v210, s49, v228
    v_dot2_f32_bf16 v229, v214, s49, v229
    v_dot2_f32_bf16 v230, v218, s49, v230
    v_dot2_f32_bf16 v231, v222, s49, v231
    v_dot2_f32_bf16 v232, v178, s49, v232
    v_dot2_f32_bf16 v233, v182, s49, v233
    v_dot2_f32_bf16 v234, v186, s49, v234
    v_dot2_f32_bf16 v235, v190, s49, v235
    v_dot2_f32_bf16 v228, v211, s49, v228
    v_dot2_f32_bf16 v229, v215, s49, v229
    v_dot2_f32_bf16 v230, v219, s49, v230
    v_dot2_f32_bf16 v231, v223, s49, v231
    v_dot2_f32_bf16 v232, v179, s49, v232
    v_dot2_f32_bf16 v233, v183, s49, v233
    v_dot2_f32_bf16 v234, v187, s49, v234
    v_dot2_f32_bf16 v235, v191, s49, v235
    s_lshl_b32 s62, s26, 9
    v_add_u32 v224, s62, v1
    v_mov_b32 v225, 1
    v_mov_b32 v226, 13312
    v_permlane32_swap_b32 v228, v230
    v_permlane32_swap_b32 v229, v231
    v_permlane32_swap_b32 v232, v234
    v_permlane32_swap_b32 v233, v235
    v_add_f32 v228, v228, v230
    v_add_f32 v229, v229, v231
    v_add_f32 v232, v232, v234
    v_add_f32 v233, v233, v235
    s_nop 0
    v_permlane16_swap_b32 v228, v229
    v_permlane16_swap_b32 v232, v233
    v_add_f32 v228, v228, v229
    v_add_f32 v232, v232, v233
    ds_write_b32 v224, v228 offset:14336
    ds_write_b32 v224, v232 offset:14592
    s_mov_b64 exec, 1
    ds_add_rtn_u32 v227, v226, v225
    s_mov_b64 exec, -1
    s_waitcnt lgkmcnt(0)
    v_readfirstlane_b32 s62, v227
    s_nop 0
    s_cmp_lg_u32 s62, 3
    s_cbranch_scc1 L_nostore_39
    ds_read_b32 v192, v1 offset:14336
    ds_read_b32 v193, v1 offset:14592
    ds_read_b32 v194, v1 offset:14848
    ds_read_b32 v195, v1 offset:15104
    ds_read_b32 v196, v1 offset:15360
    ds_read_b32 v197, v1 offset:15616
    ds_read_b32 v198, v1 offset:15872
    ds_read_b32 v199, v1 offset:16128
    v_and_b32 v224, 0xff, v2
    s_lshl4_add_u32 s62, s80, s96
    s_mov_b32 exec_lo, 0xffff
    s_mov_b32 exec_hi, 0x0
    v_add_u32 v224, s62, v224
    s_lshl4_add_u32 s62, s81, s97
    s_mov_b32 exec_lo, 0xffff0000
    s_mov_b32 exec_hi, 0x0
    v_add_u32 v224, s62, v224
    s_lshl4_add_u32 s62, s82, s100
    s_mov_b32 exec_lo, 0x0
    s_mov_b32 exec_hi, 0xffff
    v_add_u32 v224, s62, v224
    s_lshl4_add_u32 s62, s83, s101
    s_mov_b32 exec_lo, 0x0
    s_mov_b32 exec_hi, 0xffff0000
    v_add_u32 v224, s62, v224
    s_mov_b64 exec, -1
    s_lshl_b32 s92, s79, 8
    s_add_u32 s62, s92, s93
    s_waitcnt lgkmcnt(0)
    v_add_f32 v192, v192, v194
    v_add_f32 v192, v192, v196
    v_add_f32 v192, v192, v198
    v_cvt_pk_bf16_f32 v200, v192, v192
    v_lshlrev_b32 v200, 16, v200
    v_sub_f32 v200, v192, v200
    v_cvt_pk_bf16_f32 v200, v192, v200
    v_mov_b32 v201, v200
    v_mov_b32 v202, 0
    v_mov_b32 v203, 0
    buffer_store_dwordx4 v[200:203], v224, s[4:7], s92 offen sc1
    v_add_f32 v193, v193, v195
    v_add_f32 v193, v193, v197
    v_add_f32 v193, v193, v199
    v_cvt_pk_bf16_f32 v204, v193, v193
    v_lshlrev_b32 v204, 16, v204
    v_sub_f32 v204, v193, v204
    v_cvt_pk_bf16_f32 v204, v193, v204
    v_mov_b32 v205, v204
    v_mov_b32 v206, 0
    v_mov_b32 v207, 0
    buffer_store_dwordx4 v[204:207], v224, s[4:7], s62 offen sc1
L_nostore_39:
    s_mov_b32 s33, 2
    s_max_u32 s34, s34, 3
    s_sub_u32 s34, s34, 3
    s_branch L_back_24
L_hs2_33:
    v_mov_b32 v225, 1
    v_mov_b32 v226, 13316
    s_waitcnt vmcnt(0)
    s_mov_b64 exec, 1
    ds_add_rtn_u32 v227, v226, v225
    s_mov_b64 exec, -1
    s_and_b32 s23, s2, 15
    s_lshl_b32 s23, s23, 8
    s_add_u32 s23, s23, 0x1000
    s_mov_b32 s38, 1
    s_waitcnt lgkmcnt(0)
    v_readfirstlane_b32 s62, v227
    s_nop 0
    s_cmp_lg_u32 s62, 3
    s_cbranch_scc1 L_nosig_44
    s_atomic_add s38, s[14:15], s23
L_nosig_44:
    s_getpc_b64 s[98:99]
L_here_45:
    s_lshl_b32 s62, s26, 13
    v_add_u32 v228, s62, v15
    v_min_u32 v228, L_done_1 - L_here_45, v228
    v_lshlrev_b32 v229, 20, v0
    s_lshl_b32 s62, s26, 18
    global_load_dword v14, v228, s[98:99]
    buffer_load_dword v14, v229, s[4:7], 0 offen sc1
    s_mov_b64 exec, 1
    global_load_dword v14, v229, s[70:71] sc1
    s_mov_b64 exec, -1
    s_mov_b32 s33, 3
    s_max_u32 s34, s34, 3
    s_sub_u32 s34, s34, 3
    s_branch L_back_24
L_hs3_34:
    s_cmp_lg_u32 s16, 4
    s_cbranch_scc1 L_hs5_36
L_ask_46:
    v_and_b32 v224, 15, v0
    v_lshlrev_b32 v224, 8, v224
    s_mov_b32 s23, 0x8c1000
    buffer_load_dword v225, v224, s[4:7], s23 offen sc1
    s_mov_b32 s33, 4
    s_max_u32 s34, s34, 1
    s_sub_u32 s34, s34, 1
    s_branch L_back_24
L_hs4_35:
    s_waitcnt vmcnt(0)
    v_cmp_gt_u32 vcc, 16, v225
    v_mov_b32 v224, 13320
    s_cbranch_vccnz L_ask_46
    ds_write_b32 v224, v224
    s_branch L_hs6_37
L_hs5_36:
    v_mov_b32 v224, 13320
    ds_read_b32 v225, v224
    s_waitcnt lgkmcnt(0)
    v_cmp_eq_u32 vcc, 0, v225
    s_nop 0
    s_cbranch_vccz L_hs6_37
    s_mov_b32 s33, 5
    s_max_u32 s34, s34, 1
    s_sub_u32 s34, s34, 1
    s_branch L_back_24
L_hs6_37:
    s_mov_b64 exec, 0x7fffffff
    s_mov_b32 exec_lo, -1
    buffer_load_dword v14, v15, s[4:7], s51 offen sc1
    s_mov_b64 exec, -1
    buffer_load_dword v14, v15, s[4:7], s50 offen sc1
    s_add_u32 s50, s50, 8192
    buffer_load_dword v14, v15, s[4:7], s50 offen sc1
    s_add_u32 s50, s50, 8192
    s_mov_b32 s33, 7
    s_max_u32 s34, s34, 2
    s_sub_u32 s34, s34, 2
    s_branch L_back_24
L_fallback_29:
    v_add_u32 v16, 32768, v27
    v_mov_b32 v20, 0xff800000
    s_mov_b32 s31, 64
L_maxl_47:
    ds_read_b128 v[140:143], v16
    v_add_u32 v16, 1024, v16
    s_waitcnt lgkmcnt(0)
    v_mfma_f32_32x32x16_bf16 v[100:115], v[140:143], v[32:35], 0
    s_nop 15
    v_max3_f32 v20, v20, v100, v101
    v_max3_f32 v20, v20, v102, v103
    v_max3_f32 v20, v20, v104, v105
    v_max3_f32 v20, v20, v106, v107
    v_max3_f32 v20, v20, v108, v109
    v_max3_f32 v20, v20, v110, v111
    v_max3_f32 v20, v20, v112, v113
    v_max3_f32 v20, v20, v114, v115
    s_sub_u32 s31, s31, 1
    s_cmp_lg_u32 s31, 0
    s_cbranch_scc1 L_maxl_47
    v_mov_b32 v21, v20
    s_nop 1
    v_permlane32_swap_b32 v20, v21
    s_nop 1
    v_max_f32 v20, v20, v21
    v_sub_f32 v36, 0, v20
    v_mov_b32 v84, 0
    v_sub_f32 v37, 0, v20
    v_mov_b32 v85, 0
    v_sub_f32 v38, 0, v20
    v_mov_b32 v86, 0
    v_sub_f32 v39, 0, v20
    v_mov_b32 v87, 0
    v_sub_f32 v40, 0, v20
    v_mov_b32 v88, 0
    v_sub_f32 v41, 0, v20
    v_mov_b32 v89, 0
    v_sub_f32 v42, 0, v20
    v_mov_b32 v90, 0
    v_sub_f32 v43, 0, v20
    v_mov_b32 v91, 0
    v_sub_f32 v44, 0, v20
    v_mov_b32 v92, 0
    v_sub_f32 v45, 0, v20
    v_mov_b32 v93, 0
    v_sub_f32 v46, 0, v20
    v_mov_b32 v94, 0
    v_sub_f32 v47, 0, v20
    v_mov_b32 v95, 0
    v_sub_f32 v48, 0, v20
    v_mov_b32 v96, 0
    v_sub_f32 v49, 0, v20
    v_mov_b32 v97, 0
    v_sub_f32 v50, 0, v20
    v_mov_b32 v98, 0
    v_sub_f32 v51, 0, v20
    v_mov_b32 v99, 0
    v_add_u32 v16, 32768, v27
    v_mov_b32 v17, v19
    v_lshrrev_b32 v18, 1, v18
    s_mov_b32 s31, 64
L_pass2_48:
    ds_read_b128 v[140:143], v16
    ds_read_b128 v[148:151], v17
    ds_read_b128 v[152:155], v17 offset:512
    v_add_u32 v16, 1024, v16
    v_add_u32 v17, v18, v17
    s_waitcnt lgkmcnt(0)
    v_mfma_f32_32x32x16_bf16 v[100:115], v[140:143], v[32:35], v[36:51]
    s_nop 15
    v_exp_f32 v100, v100
    v_exp_f32 v101, v101
    v_exp_f32 v102, v102
    v_exp_f32 v103, v103
    v_exp_f32 v104, v104
    v_exp_f32 v105, v105
    v_exp_f32 v106, v106
    v_exp_f32 v107, v107
    v_exp_f32 v108, v108
    v_exp_f32 v109, v109
    v_exp_f32 v110, v110
    v_exp_f32 v111, v111
    v_exp_f32 v112, v112
    v_exp_f32 v113, v113
    v_exp_f32 v114, v114
    v_exp_f32 v115, v115
    s_nop 2
    v_smfmac_f32_32x32x32_bf16 v[84:99], v[148:151], v[100:107], v26
    v_smfmac_f32_32x32x32_bf16 v[84:99], v[152:155], v[108:115], v26
    s_sub_u32 s31, s31, 1
    s_cmp_lg_u32 s31, 0
    s_nop 7
    s_cbranch_scc1 L_pass2_48
    s_nop 15
    v_rcp_f32 v20, v92
    s_nop 0
    s_branch L_fin_28
L_att_end_30:
    s_and_b32 s68, s18, 3
    s_lshr_b32 s19, s17, 1
    s_lshl_b32 s19, s19, 2
    s_add_u32 s68, s68, s19
    s_lshl_b32 s68, s68, 2
    s_lshr_b32 s69, s18, 2
    s_and_b32 s19, s17, 1
    s_mul_i32 s19, s19, 8
    s_add_u32 s69, s69, s19
    s_cmp_lt_u32 s16, 4
    s_cbranch_scc1 L_oproj_comp_49
    s_and_b32 s19, s16, 3
    s_lshl_b32 s25, s19, 12
    s_mul_i32 s23, s44, 65536
    s_add_u32 s23, s23, s25
    s_add_u32 s23, s23, 0x200000
    s_add_u32 s26, s25, 81920
    s_mov_b32 m0, s26
    s_add_u32 s27, s23, 0
    buffer_load_dwordx4 v2, s[4:7], s27 offen offset:0 sc1 lds
    buffer_load_dwordx4 v2, s[4:7], s27 offen offset:1024 sc1 lds
    buffer_load_dwordx4 v2, s[4:7], s27 offen offset:2048 sc1 lds
    buffer_load_dwordx4 v2, s[4:7], s27 offen offset:3072 sc1 lds
    s_add_u32 s26, s25, 98304
    s_mov_b32 m0, s26
    s_add_u32 s27, s23, 16384
    buffer_load_dwordx4 v2, s[4:7], s27 offen offset:0 sc1 lds
    buffer_load_dwordx4 v2, s[4:7], s27 offen offset:1024 sc1 lds
    buffer_load_dwordx4 v2, s[4:7], s27 offen offset:2048 sc1 lds
    buffer_load_dwordx4 v2, s[4:7], s27 offen offset:3072 sc1 lds
    s_waitcnt vmcnt(8)
    s_mov_b32 s38, 1
    s_atomic_add s38, s[14:15], s48
    s_add_u32 s26, s25, 114688
    s_mov_b32 m0, s26
    s_add_u32 s27, s23, 32768
    buffer_load_dwordx4 v2, s[4:7], s27 offen offset:0 sc1 lds
    buffer_load_dwordx4 v2, s[4:7], s27 offen offset:1024 sc1 lds
    buffer_load_dwordx4 v2, s[4:7], s27 offen offset:2048 sc1 lds
    buffer_load_dwordx4 v2, s[4:7], s27 offen offset:3072 sc1 lds
    s_add_u32 s26, s25, 131072
    s_mov_b32 m0, s26
    s_add_u32 s27, s23, 49152
    buffer_load_dwordx4 v2, s[4:7], s27 offen offset:0 sc1 lds
    buffer_load_dwordx4 v2, s[4:7], s27 offen offset:1024 sc1 lds
    buffer_load_dwordx4 v2, s[4:7], s27 offen offset:2048 sc1 lds
    buffer_load_dwordx4 v2, s[4:7], s27 offen offset:3072 sc1 lds
    s_and_b32 s19, s16, 3
    s_lshl_b32 s25, s19, 12
    s_mul_i32 s20, s69, 243712
    s_add_u32 s20, s20, s25
    s_add_u32 s20, s20, 0x300000
    s_mul_i32 s21, s44, 229376
    s_add_u32 s21, s21, s25
    s_add_u32 s21, s21, 0x700000
    v_add_u32 v16, 0, v2
    v_add_u32 v16, s25, v16
    v_add_u32 v17, 65536, v2
    v_add_u32 v17, s25, v17
    v_add_u32 v18, 131072, v2
    v_add_u32 v18, s25, v18
    s_add_u32 s26, s25, 0
    s_mov_b32 m0, s26
    s_add_u32 s27, s20, 0
    buffer_load_dwordx4 v2, s[4:7], s27 offen offset:0 sc1 lds
    buffer_load_dwordx4 v2, s[4:7], s27 offen offset:1024 sc1 lds
    buffer_load_dwordx4 v2, s[4:7], s27 offen offset:2048 sc1 lds
    buffer_load_dwordx4 v2, s[4:7], s27 offen offset:3072 sc1 lds
    s_add_u32 s26, s25, 16384
    s_mov_b32 m0, s26
    s_add_u32 s27, s20, 16384
    buffer_load_dwordx4 v2, s[4:7], s27 offen offset:0 sc1 lds
    buffer_load_dwordx4 v2, s[4:7], s27 offen offset:1024 sc1 lds
    buffer_load_dwordx4 v2, s[4:7], s27 offen offset:2048 sc1 lds
    buffer_load_dwordx4 v2, s[4:7], s27 offen offset:3072 sc1 lds
    s_add_u32 s26, s25, 32768
    s_mov_b32 m0, s26
    s_add_u32 s27, s20, 32768
    buffer_load_dwordx4 v2, s[4:7], s27 offen offset:0 sc1 lds
    buffer_load_dwordx4 v2, s[4:7], s27 offen offset:1024 sc1 lds
    buffer_load_dwordx4 v2, s[4:7], s27 offen offset:2048 sc1 lds
    buffer_load_dwordx4 v2, s[4:7], s27 offen offset:3072 sc1 lds
    s_add_u32 s26, s25, 49152
    s_mov_b32 m0, s26
    s_add_u32 s27, s20, 49152
    buffer_load_dwordx4 v2, s[4:7], s27 offen offset:0 sc1 lds
    buffer_load_dwordx4 v2, s[4:7], s27 offen offset:1024 sc1 lds
    buffer_load_dwordx4 v2, s[4:7], s27 offen offset:2048 sc1 lds
    buffer_load_dwordx4 v2, s[4:7], s27 offen offset:3072 sc1 lds
    s_waitcnt vmcnt(16)
    s_barrier
    s_barrier
    s_add_u32 s26, s25, 65536
    s_mov_b32 m0, s26
    s_add_u32 s27, s20, 65536
    buffer_load_dwordx4 v2, s[4:7], s27 offen offset:0 sc1 lds
    buffer_load_dwordx4 v2, s[4:7], s27 offen offset:1024 sc1 lds
    buffer_load_dwordx4 v2, s[4:7], s27 offen offset:2048 sc1 lds
    buffer_load_dwordx4 v2, s[4:7], s27 offen offset:3072 sc1 lds
    s_barrier
    s_branch L_oproj_end_50
L_oproj_comp_49:
    s_and_b32 s24, s16, 1
    s_lshr_b32 s25, s16, 1
    s_lshl_b32 s33, s44, 1
    s_add_u32 s33, s33, s25
    s_add_u32 s31, s43, s24
    s_lshl_b32 s22, s31, 15
    s_lshl_b32 s27, s25, 11
    s_add_u32 s22, s22, s27
    s_mul_i32 s26, s25, 6144
    s_add_u32 s27, s27, 2048
    v_add_u32 v22, 0, v2
    v_add_u32 v16, s26, v22
    v_add_u32 v19, s27, v22
    v_add_u32 v22, 65536, v2
    v_add_u32 v17, s26, v22
    v_add_u32 v20, s27, v22
    v_add_u32 v22, 131072, v2
    v_add_u32 v18, s26, v22
    v_add_u32 v21, s27, v22
    v_lshlrev_b32 v32, 16, v4
    v_and_b32 v33, 0xffff0000, v4
    v_lshlrev_b32 v34, 16, v5
    v_and_b32 v35, 0xffff0000, v5
    v_lshlrev_b32 v40, 16, v6
    v_and_b32 v41, 0xffff0000, v6
    v_lshlrev_b32 v42, 16, v7
    v_and_b32 v43, 0xffff0000, v7
    v_lshlrev_b32 v36, 16, v8
    v_and_b32 v37, 0xffff0000, v8
    v_lshlrev_b32 v38, 16, v9
    v_and_b32 v39, 0xffff0000, v9
    v_lshlrev_b32 v44, 16, v10
    v_and_b32 v45, 0xffff0000, v10
    v_lshlrev_b32 v46, 16, v11
    v_and_b32 v47, 0xffff0000, v11
    s_lshl_b32 s26, s16, 12
    s_add_u32 s26, s26, 147456
    s_xor_b32 s27, s26, 0x2000
    v_add_u32 v22, s26, v2
    v_add_u32 v23, s27, v2
    s_add_u32 s22, s22, s41
    s_add_u32 s22, s22, 0x600000
    s_lshl_b32 s23, s31, 8
    s_add_u32 s23, s23, s42
    s_add_u32 s23, s23, 0x8000
    s_waitcnt vmcnt(0)
    s_mov_b32 s38, 1
    s_atomic_add s38, s[14:15], s48
    s_mov_b32 s39, 1048576
L_poll_51:
    s_mov_b32 s49, 0
    s_atomic_add s49, s[14:15], s23 glc
    s_sub_u32 s39, s39, 1
    s_waitcnt lgkmcnt(0)
    s_cmp_ge_u32 s49, 32
    s_cbranch_scc1 L_pok_52
    s_sleep 1
    s_cmp_lg_u32 s39, 0
    s_cbranch_scc1 L_poll_51
L_pok_52:
    buffer_load_dwordx4 v[96:99], v15, s[4:7], s22 offen offset:0 sc1
    buffer_load_dwordx4 v[100:103], v15, s[4:7], s22 offen offset:256 sc1
    s_add_u32 s22, s22, 4096
    buffer_load_dwordx4 v[104:107], v15, s[4:7], s22 offen offset:0 sc1
    buffer_load_dwordx4 v[108:111], v15, s[4:7], s22 offen offset:256 sc1
    s_add_u32 s22, s22, 4096
    buffer_load_dwordx4 v[112:115], v15, s[4:7], s22 offen offset:0 sc1
    buffer_load_dwordx4 v[116:119], v15, s[4:7], s22 offen offset:256 sc1
    s_add_u32 s22, s22, 4096
    buffer_load_dwordx4 v[120:123], v15, s[4:7], s22 offen offset:0 sc1
    buffer_load_dwordx4 v[124:127], v15, s[4:7], s22 offen offset:256 sc1
    s_add_u32 s22, s22, 4096
    s_barrier
    ds_read_b128 v[64:67], v17 offset:16384
    ds_read_b128 v[68:71], v17 offset:17408
    ds_read_b128 v[72:75], v20 offset:16384
    ds_read_b128 v[76:79], v20 offset:17408
    ds_read_b128 v[80:83], v17 offset:24576
    ds_read_b128 v[84:87], v17 offset:25600
    s_lshl_b32 s48, s31, 8
    s_add_u32 s48, s48, s42
    s_add_u32 s48, s48, 0x8004
    s_waitcnt lgkmcnt(4)
    s_waitcnt vmcnt(6)
    v_mfma_f32_16x16x32_bf16 v[32:35], v[64:67], v[96:99], v[32:35]
    ds_read_b128 v[88:91], v20 offset:24576
    v_mfma_f32_16x16x32_bf16 v[36:39], v[64:67], v[100:103], v[36:39]
    buffer_load_dwordx4 v[128:131], v15, s[4:7], s22 offen offset:0 sc1
    v_mfma_f32_16x16x32_bf16 v[40:43], v[68:71], v[96:99], v[40:43]
    ds_read_b128 v[92:95], v20 offset:25600
    v_mfma_f32_16x16x32_bf16 v[44:47], v[68:71], v[100:103], v[44:47]
    buffer_load_dwordx4 v[132:135], v15, s[4:7], s22 offen offset:256 sc1
    s_add_u32 s22, s22, 4096
    s_waitcnt lgkmcnt(4)
    v_mfma_f32_16x16x32_bf16 v[48:51], v[72:75], v[96:99], 0
    ds_read_b128 v[64:67], v17 offset:32768
    v_mfma_f32_16x16x32_bf16 v[52:55], v[72:75], v[100:103], 0
    buffer_load_dwordx4 v[136:139], v15, s[4:7], s22 offen offset:0 sc1
    v_mfma_f32_16x16x32_bf16 v[56:59], v[76:79], v[96:99], 0
    ds_read_b128 v[68:71], v17 offset:33792
    v_mfma_f32_16x16x32_bf16 v[60:63], v[76:79], v[100:103], 0
    buffer_load_dwordx4 v[140:143], v15, s[4:7], s22 offen offset:256 sc1
    s_add_u32 s22, s22, 4096
    s_waitcnt lgkmcnt(4)
    s_waitcnt vmcnt(8)
    v_mfma_f32_16x16x32_bf16 v[32:35], v[80:83], v[104:107], v[32:35]
    ds_read_b128 v[72:75], v20 offset:32768
    v_mfma_f32_16x16x32_bf16 v[36:39], v[80:83], v[108:111], v[36:39]
    buffer_load_dwordx4 v[144:147], v15, s[4:7], s22 offen offset:0 sc1
    v_mfma_f32_16x16x32_bf16 v[40:43], v[84:87], v[104:107], v[40:43]
    ds_read_b128 v[76:79], v20 offset:33792
    v_mfma_f32_16x16x32_bf16 v[44:47], v[84:87], v[108:111], v[44:47]
    buffer_load_dwordx4 v[148:151], v15, s[4:7], s22 offen offset:256 sc1
    s_add_u32 s22, s22, 4096
    s_waitcnt lgkmcnt(4)
    v_mfma_f32_16x16x32_bf16 v[48:51], v[88:91], v[104:107], v[48:51]
    ds_read_b128 v[80:83], v17 offset:40960
    v_mfma_f32_16x16x32_bf16 v[52:55], v[88:91], v[108:111], v[52:55]
    buffer_load_dwordx4 v[152:155], v15, s[4:7], s22 offen offset:0 sc1
    v_mfma_f32_16x16x32_bf16 v[56:59], v[92:95], v[104:107], v[56:59]
    ds_read_b128 v[84:87], v17 offset:41984
    v_mfma_f32_16x16x32_bf16 v[60:63], v[92:95], v[108:111], v[60:63]
    buffer_load_dwordx4 v[156:159], v15, s[4:7], s22 offen offset:256 sc1
    s_add_u32 s22, s22, 4096
    s_waitcnt lgkmcnt(4)
    s_waitcnt vmcnt(10)
    v_mfma_f32_16x16x32_bf16 v[32:35], v[64:67], v[112:115], v[32:35]
    ds_read_b128 v[88:91], v20 offset:40960
    v_mfma_f32_16x16x32_bf16 v[36:39], v[64:67], v[116:119], v[36:39]
    v_mfma_f32_16x16x32_bf16 v[40:43], v[68:71], v[112:115], v[40:43]
    ds_read_b128 v[92:95], v20 offset:41984
    v_mfma_f32_16x16x32_bf16 v[44:47], v[68:71], v[116:119], v[44:47]
    s_waitcnt lgkmcnt(4)
    v_mfma_f32_16x16x32_bf16 v[48:51], v[72:75], v[112:115], v[48:51]
    ds_read_b128 v[64:67], v20 offset:49152
    v_mfma_f32_16x16x32_bf16 v[52:55], v[72:75], v[116:119], v[52:55]
    v_mfma_f32_16x16x32_bf16 v[56:59], v[76:79], v[112:115], v[56:59]
    ds_read_b128 v[68:71], v20 offset:50176
    v_mfma_f32_16x16x32_bf16 v[60:63], v[76:79], v[116:119], v[60:63]
    s_waitcnt lgkmcnt(4)
    s_waitcnt vmcnt(8)
    v_mfma_f32_16x16x32_bf16 v[32:35], v[80:83], v[120:123], v[32:35]
    ds_read_b128 v[72:75], v20 offset:57344
    v_mfma_f32_16x16x32_bf16 v[36:39], v[80:83], v[124:127], v[36:39]
    v_mfma_f32_16x16x32_bf16 v[40:43], v[84:87], v[120:123], v[40:43]
    ds_read_b128 v[76:79], v20 offset:58368
    v_mfma_f32_16x16x32_bf16 v[44:47], v[84:87], v[124:127], v[44:47]
    s_waitcnt lgkmcnt(4)
    v_mfma_f32_16x16x32_bf16 v[48:51], v[88:91], v[120:123], v[48:51]
    ds_read_b128 v[80:83], v21 offset:0
    v_mfma_f32_16x16x32_bf16 v[52:55], v[88:91], v[124:127], v[52:55]
    v_mfma_f32_16x16x32_bf16 v[56:59], v[92:95], v[120:123], v[56:59]
    ds_read_b128 v[84:87], v21 offset:1024
    v_mfma_f32_16x16x32_bf16 v[60:63], v[92:95], v[124:127], v[60:63]
    s_waitcnt lgkmcnt(4)
    s_waitcnt vmcnt(6)
    v_mfma_f32_16x16x32_bf16 v[48:51], v[64:67], v[128:131], v[48:51]
    ds_read_b128 v[88:91], v21 offset:8192
    v_mfma_f32_16x16x32_bf16 v[52:55], v[64:67], v[132:135], v[52:55]
    v_mfma_f32_16x16x32_bf16 v[56:59], v[68:71], v[128:131], v[56:59]
    ds_read_b128 v[92:95], v21 offset:9216
    v_mfma_f32_16x16x32_bf16 v[60:63], v[68:71], v[132:135], v[60:63]
    s_waitcnt lgkmcnt(4)
    s_waitcnt vmcnt(4)
    v_mfma_f32_16x16x32_bf16 v[48:51], v[72:75], v[136:139], v[48:51]
    ds_read_b128 v[64:67], v17 offset:49152
    v_mfma_f32_16x16x32_bf16 v[52:55], v[72:75], v[140:143], v[52:55]
    v_mfma_f32_16x16x32_bf16 v[56:59], v[76:79], v[136:139], v[56:59]
    ds_read_b128 v[68:71], v17 offset:50176
    v_mfma_f32_16x16x32_bf16 v[60:63], v[76:79], v[140:143], v[60:63]
    s_waitcnt lgkmcnt(4)
    s_waitcnt vmcnt(2)
    v_mfma_f32_16x16x32_bf16 v[48:51], v[80:83], v[144:147], v[48:51]
    ds_read_b128 v[72:75], v17 offset:57344
    v_mfma_f32_16x16x32_bf16 v[52:55], v[80:83], v[148:151], v[52:55]
    v_mfma_f32_16x16x32_bf16 v[56:59], v[84:87], v[144:147], v[56:59]
    ds_read_b128 v[76:79], v17 offset:58368
    v_mfma_f32_16x16x32_bf16 v[60:63], v[84:87], v[148:151], v[60:63]
    s_waitcnt lgkmcnt(4)
    s_waitcnt vmcnt(0)
    v_mfma_f32_16x16x32_bf16 v[48:51], v[88:91], v[152:155], v[48:51]
    ds_read_b128 v[80:83], v18 offset:0
    v_mfma_f32_16x16x32_bf16 v[52:55], v[88:91], v[156:159], v[52:55]
    v_mfma_f32_16x16x32_bf16 v[56:59], v[92:95], v[152:155], v[56:59]
    ds_read_b128 v[84:87], v18 offset:1024
    v_mfma_f32_16x16x32_bf16 v[60:63], v[92:95], v[156:159], v[60:63]
    s_waitcnt lgkmcnt(4)
    v_mfma_f32_16x16x32_bf16 v[32:35], v[64:67], v[128:131], v[32:35]
    ds_read_b128 v[88:91], v18 offset:8192
    v_mfma_f32_16x16x32_bf16 v[36:39], v[64:67], v[132:135], v[36:39]
    v_mfma_f32_16x16x32_bf16 v[40:43], v[68:71], v[128:131], v[40:43]
    ds_read_b128 v[92:95], v18 offset:9216
    v_mfma_f32_16x16x32_bf16 v[44:47], v[68:71], v[132:135], v[44:47]
    s_waitcnt lgkmcnt(4)
    v_mfma_f32_16x16x32_bf16 v[32:35], v[72:75], v[136:139], v[32:35]
    ds_write_b128 v22, v[48:51] offset:0
    v_mfma_f32_16x16x32_bf16 v[36:39], v[72:75], v[140:143], v[36:39]
    ds_write_b128 v22, v[52:55] offset:1024
    v_mfma_f32_16x16x32_bf16 v[40:43], v[76:79], v[136:139], v[40:43]
    ds_write_b128 v22, v[56:59] offset:2048
    v_mfma_f32_16x16x32_bf16 v[44:47], v[76:79], v[140:143], v[44:47]
    ds_write_b128 v22, v[60:63] offset:3072
    s_waitcnt lgkmcnt(6)
    v_mfma_f32_16x16x32_bf16 v[32:35], v[80:83], v[144:147], v[32:35]
    v_mfma_f32_16x16x32_bf16 v[36:39], v[80:83], v[148:151], v[36:39]
    v_mfma_f32_16x16x32_bf16 v[40:43], v[84:87], v[144:147], v[40:43]
    v_mfma_f32_16x16x32_bf16 v[44:47], v[84:87], v[148:151], v[44:47]
    s_waitcnt lgkmcnt(4)
    s_waitcnt lgkmcnt(0)
    s_barrier
    ds_read_b128 v[48:51], v23 offset:0
    ds_read_b128 v[52:55], v23 offset:1024
    ds_read_b128 v[56:59], v23 offset:2048
    ds_read_b128 v[60:63], v23 offset:3072
    v_mfma_f32_16x16x32_bf16 v[32:35], v[88:91], v[152:155], v[32:35]
    v_mfma_f32_16x16x32_bf16 v[36:39], v[88:91], v[156:159], v[36:39]
    v_mfma_f32_16x16x32_bf16 v[40:43], v[92:95], v[152:155], v[40:43]
    v_mfma_f32_16x16x32_bf16 v[44:47], v[92:95], v[156:159], v[44:47]
    s_lshl_b32 s26, s31, 15
    s_lshl_b32 s27, s33, 11
    s_add_u32 s26, s26, s27
    s_add_u32 s26, s26, s41
    s_add_u32 s26, s26, 0x800000
    s_lshl_b32 s28, s31, 12
    s_lshl_b32 s29, s33, 8
    s_add_u32 s28, s28, s29
    s_waitcnt lgkmcnt(0)
    v_pk_add_f32 v[32:33], v[32:33], v[48:49]
    v_pk_add_f32 v[34:35], v[34:35], v[50:51]
    v_pk_add_f32 v[36:37], v[36:37], v[52:53]
    v_pk_add_f32 v[38:39], v[38:39], v[54:55]
    v_pk_add_f32 v[40:41], v[40:41], v[56:57]
    v_pk_add_f32 v[42:43], v[42:43], v[58:59]
    v_pk_add_f32 v[44:45], v[44:45], v[60:61]
    v_pk_add_f32 v[46:47], v[46:47], v[62:63]
    v_cvt_pk_bf16_f32 v4, v32, v33
    v_cvt_pk_bf16_f32 v5, v34, v35
    v_cvt_pk_bf16_f32 v6, v40, v41
    v_cvt_pk_bf16_f32 v7, v42, v43
    v_cvt_pk_bf16_f32 v8, v36, v37
    v_cvt_pk_bf16_f32 v9, v38, v39
    v_cvt_pk_bf16_f32 v10, v44, v45
    v_cvt_pk_bf16_f32 v11, v46, v47
    buffer_store_dwordx4 v[4:7], v15, s[4:7], s26 offen sc1
    buffer_store_dwordx4 v[8:11], v15, s[4:7], s26 offen offset:256 sc1
    v_pk_mul_f32 v[160:161], v[32:33], v[32:33]
    v_pk_mul_f32 v[162:163], v[36:37], v[36:37]
    v_pk_fma_f32 v[160:161], v[34:35], v[34:35], v[160:161]
    v_pk_add_f32 v[32:33], v[32:33], v[34:35]
    v_pk_fma_f32 v[162:163], v[38:39], v[38:39], v[162:163]
    v_pk_add_f32 v[36:37], v[36:37], v[38:39]
    v_pk_fma_f32 v[160:161], v[40:41], v[40:41], v[160:161]
    v_pk_add_f32 v[32:33], v[32:33], v[40:41]
    v_pk_fma_f32 v[162:163], v[44:45], v[44:45], v[162:163]
    v_pk_add_f32 v[36:37], v[36:37], v[44:45]
    v_pk_fma_f32 v[160:161], v[42:43], v[42:43], v[160:161]
    v_pk_add_f32 v[32:33], v[32:33], v[42:43]
    v_pk_fma_f32 v[162:163], v[46:47], v[46:47], v[162:163]
    v_pk_add_f32 v[36:37], v[36:37], v[46:47]
    v_add_f32 v164, v32, v33
    v_add_f32 v165, v36, v37
    v_add_f32 v166, v160, v161
    v_add_f32 v167, v162, v163
    v_permlane32_swap_b32 v164, v165
    s_add_u32 s28, s28, s41
    v_permlane32_swap_b32 v166, v167
    v_add_f32 v164, v164, v165
    v_add_f32 v166, v166, v167
    s_add_u32 s28, s28, 0x1300000
    s_nop 0
    v_permlane16_swap_b32 v164, v166
    s_nop 0
    v_add_f32 v164, v164, v166
    buffer_store_dword v164, v3, s[4:7], s28 offen sc1
    s_barrier
L_oproj_end_50:
    s_cmp_lt_u32 s16, 4
    s_cbranch_scc1 L_mlp_comp_54
    s_add_u32 s26, s25, 81920
    s_mov_b32 m0, s26
    s_add_u32 s27, s20, 81920
    buffer_load_dwordx4 v2, s[4:7], s27 offen offset:0 sc1 lds
    buffer_load_dwordx4 v2, s[4:7], s27 offen offset:1024 sc1 lds
    buffer_load_dwordx4 v2, s[4:7], s27 offen offset:2048 sc1 lds
    buffer_load_dwordx4 v2, s[4:7], s27 offen offset:3072 sc1 lds
    s_add_u32 s26, s25, 98304
    s_mov_b32 m0, s26
    s_add_u32 s27, s20, 98304
    buffer_load_dwordx4 v2, s[4:7], s27 offen offset:0 sc1 lds
    buffer_load_dwordx4 v2, s[4:7], s27 offen offset:1024 sc1 lds
    buffer_load_dwordx4 v2, s[4:7], s27 offen offset:2048 sc1 lds
    buffer_load_dwordx4 v2, s[4:7], s27 offen offset:3072 sc1 lds
    s_add_u32 s26, s25, 114688
    s_mov_b32 m0, s26
    s_add_u32 s27, s20, 114688
    buffer_load_dwordx4 v2, s[4:7], s27 offen offset:0 sc1 lds
    buffer_load_dwordx4 v2, s[4:7], s27 offen offset:1024 sc1 lds
    buffer_load_dwordx4 v2, s[4:7], s27 offen offset:2048 sc1 lds
    buffer_load_dwordx4 v2, s[4:7], s27 offen offset:3072 sc1 lds
    s_add_u32 s26, s25, 131072
    s_mov_b32 m0, s26
    s_add_u32 s27, s20, 131072
    buffer_load_dwordx4 v2, s[4:7], s27 offen offset:0 sc1 lds
    buffer_load_dwordx4 v2, s[4:7], s27 offen offset:1024 sc1 lds
    buffer_load_dwordx4 v2, s[4:7], s27 offen offset:2048 sc1 lds
    buffer_load_dwordx4 v2, s[4:7], s27 offen offset:3072 sc1 lds
    s_add_u32 s26, s25, 147456
    s_mov_b32 m0, s26
    s_add_u32 s27, s20, 147456
    buffer_load_dwordx4 v2, s[4:7], s27 offen offset:0 sc1 lds
    buffer_load_dwordx4 v2, s[4:7], s27 offen offset:1024 sc1 lds
    buffer_load_dwordx4 v2, s[4:7], s27 offen offset:2048 sc1 lds
    buffer_load_dwordx4 v2, s[4:7], s27 offen offset:3072 sc1 lds
    s_add_u32 s27, s20, 163840
    buffer_load_dwordx4 v[32:35], v2, s[4:7], s27 offen offset:0 sc1
    buffer_load_dwordx4 v[36:39], v2, s[4:7], s27 offen offset:1024 sc1
    buffer_load_dwordx4 v[40:43], v2, s[4:7], s27 offen offset:2048 sc1
    buffer_load_dwordx4 v[44:47], v2, s[4:7], s27 offen offset:3072 sc1
    s_add_u32 s27, s20, 180224
    buffer_load_dwordx4 v[48:51], v2, s[4:7], s27 offen offset:0 sc1
    buffer_load_dwordx4 v[52:55], v2, s[4:7], s27 offen offset:1024 sc1
    buffer_load_dwordx4 v[56:59], v2, s[4:7], s27 offen offset:2048 sc1
    buffer_load_dwordx4 v[60:63], v2, s[4:7], s27 offen offset:3072 sc1
    s_add_u32 s27, s20, 196608
    buffer_load_dwordx4 v[64:67], v2, s[4:7], s27 offen offset:0 sc1
    buffer_load_dwordx4 v[68:71], v2, s[4:7], s27 offen offset:1024 sc1
    buffer_load_dwordx4 v[72:75], v2, s[4:7], s27 offen offset:2048 sc1
    buffer_load_dwordx4 v[76:79], v2, s[4:7], s27 offen offset:3072 sc1
    s_waitcnt vmcnt(44)
    s_barrier
    s_add_u32 s22, s68, s19
    s_lshl_b32 s22, s22, 12
    s_add_u32 s22, s22, s41
    s_add_u32 s22, s22, 0x1300000
    buffer_load_dwordx4 v[160:163], v2, s[4:7], s22 offen offset:0 sc1
    buffer_load_dwordx4 v[164:167], v2, s[4:7], s22 offen offset:1024 sc1
    buffer_load_dwordx4 v[168:171], v2, s[4:7], s22 offen offset:2048 sc1
    buffer_load_dwordx4 v[172:175], v2, s[4:7], s22 offen offset:3072 sc1
    s_waitcnt vmcnt(44)
    s_barrier
    s_waitcnt vmcnt(0)
    v_add_f32 v160, v160, v168
    v_add_f32 v161, v161, v169
    v_add_f32 v162, v162, v170
    v_add_f32 v163, v163, v171
    v_add_f32 v164, v164, v172
    v_add_f32 v165, v165, v173
    v_add_f32 v166, v166, v174
    v_add_f32 v167, v167, v175
    v_add_f32 v160, v160, v164
    v_add_f32 v161, v161, v165
    v_add_f32 v162, v162, v166
    v_add_f32 v163, v163, v167
    s_nop 1
    v_permlane32_swap_b32 v160, v162
    v_permlane32_swap_b32 v161, v163
    v_add_f32 v160, v160, v162
    v_add_f32 v161, v161, v163
    v_mov_b32 v162, v160
    v_mov_b32 v163, v161
    s_nop 1
    v_permlane16_swap_b32 v160, v162
    v_permlane16_swap_b32 v161, v163
    v_add_f32 v160, v160, v162
    v_add_f32 v161, v161, v163
    v_mul_f32 v160, 0xbb000000, v160
    v_mul_f32 v161, 0x3b000000, v161
    v_fma_f32 v161, -v160, v160, v161
    v_max_f32 v161, 0, v161
    v_add_f32 v161, 0x3727c5ac, v161
    v_rcp_f32 v22, v161
    v_cvt_pk_bf16_f32 v20, v160, v160
    v_lshlrev_b32 v162, 16, v20
    v_sub_f32 v162, v160, v162
    v_cvt_pk_bf16_f32 v21, v162, v162
    ds_write_b128 v16, v[20:23]
    s_waitcnt lgkmcnt(0)
    s_barrier
    s_barrier
    ds_write_b128 v16, v[32:35] offset:0
    s_waitcnt lgkmcnt(0)
    ds_write_b128 v16, v[36:39] offset:1024
    s_waitcnt lgkmcnt(0)
    ds_write_b128 v16, v[40:43] offset:2048
    s_waitcnt lgkmcnt(0)
    ds_write_b128 v16, v[44:47] offset:3072
    s_waitcnt lgkmcnt(0)
    s_barrier
    ds_write_b128 v16, v[48:51] offset:16384
    s_waitcnt lgkmcnt(0)
    ds_write_b128 v16, v[52:55] offset:17408
    s_waitcnt lgkmcnt(0)
    ds_write_b128 v16, v[56:59] offset:18432
    s_waitcnt lgkmcnt(0)
    ds_write_b128 v16, v[60:63] offset:19456
    s_waitcnt lgkmcnt(0)
    s_barrier
    ds_write_b128 v16, v[64:67] offset:32768
    s_waitcnt lgkmcnt(0)
    ds_write_b128 v16, v[68:71] offset:33792
    s_waitcnt lgkmcnt(0)
    ds_write_b128 v16, v[72:75] offset:34816
    s_waitcnt lgkmcnt(0)
    ds_write_b128 v16, v[76:79] offset:35840
    s_waitcnt lgkmcnt(0)
    s_barrier
    s_add_u32 s26, s25, 49152
    s_mov_b32 m0, s26
    s_add_u32 s27, s20, 212992
    buffer_load_dwordx4 v2, s[4:7], s27 offen offset:0 sc1 lds
    buffer_load_dwordx4 v2, s[4:7], s27 offen offset:1024 sc1 lds
    buffer_load_dwordx4 v2, s[4:7], s27 offen offset:2048 sc1 lds
    buffer_load_dwordx4 v2, s[4:7], s27 offen offset:3072 sc1 lds
    s_add_u32 s26, s25, 65536
    s_mov_b32 m0, s26
    s_add_u32 s27, s20, 229376
    buffer_load_dwordx4 v2, s[4:7], s27 offen offset:0 sc1 lds
    buffer_load_dwordx4 v2, s[4:7], s27 offen offset:1024 sc1 lds
    buffer_load_dwordx4 v2, s[4:7], s27 offen offset:2048 sc1 lds
    buffer_load_dwordx4 v2, s[4:7], s27 offen offset:3072 sc1 lds
    s_add_u32 s26, s25, 81920
    s_mov_b32 m0, s26
    s_add_u32 s27, s21, 0
    buffer_load_dwordx4 v2, s[4:7], s27 offen offset:0 sc1 lds
    buffer_load_dwordx4 v2, s[4:7], s27 offen offset:1024 sc1 lds
    buffer_load_dwordx4 v2, s[4:7], s27 offen offset:2048 sc1 lds
    buffer_load_dwordx4 v2, s[4:7], s27 offen offset:3072 sc1 lds
    s_barrier
    s_add_u32 s26, s25, 98304
    s_mov_b32 m0, s26
    s_add_u32 s27, s21, 16384
    buffer_load_dwordx4 v2, s[4:7], s27 offen offset:0 sc1 lds
    buffer_load_dwordx4 v2, s[4:7], s27 offen offset:1024 sc1 lds
    buffer_load_dwordx4 v2, s[4:7], s27 offen offset:2048 sc1 lds
    buffer_load_dwordx4 v2, s[4:7], s27 offen offset:3072 sc1 lds
    s_barrier
    s_add_u32 s26, s25, 114688
    s_mov_b32 m0, s26
    s_add_u32 s27, s21, 32768
    buffer_load_dwordx4 v2, s[4:7], s27 offen offset:0 sc1 lds
    buffer_load_dwordx4 v2, s[4:7], s27 offen offset:1024 sc1 lds
    buffer_load_dwordx4 v2, s[4:7], s27 offen offset:2048 sc1 lds
    buffer_load_dwordx4 v2, s[4:7], s27 offen offset:3072 sc1 lds
    s_waitcnt lgkmcnt(0)
    s_barrier
    s_add_u32 s26, s25, 131072
    s_mov_b32 m0, s26
    s_add_u32 s27, s21, 49152
    buffer_load_dwordx4 v2, s[4:7], s27 offen offset:0 sc1 lds
    buffer_load_dwordx4 v2, s[4:7], s27 offen offset:1024 sc1 lds
    buffer_load_dwordx4 v2, s[4:7], s27 offen offset:2048 sc1 lds
    buffer_load_dwordx4 v2, s[4:7], s27 offen offset:3072 sc1 lds
    s_barrier
    s_add_u32 s26, s25, 147456
    s_mov_b32 m0, s26
    s_add_u32 s27, s21, 65536
    buffer_load_dwordx4 v2, s[4:7], s27 offen offset:0 sc1 lds
    buffer_load_dwordx4 v2, s[4:7], s27 offen offset:1024 sc1 lds
    buffer_load_dwordx4 v2, s[4:7], s27 offen offset:2048 sc1 lds
    buffer_load_dwordx4 v2, s[4:7], s27 offen offset:3072 sc1 lds
    s_barrier
    s_add_u32 s26, s25, 0
    s_mov_b32 m0, s26
    s_add_u32 s27, s21, 81920
    buffer_load_dwordx4 v2, s[4:7], s27 offen offset:0 sc1 lds
    buffer_load_dwordx4 v2, s[4:7], s27 offen offset:1024 sc1 lds
    buffer_load_dwordx4 v2, s[4:7], s27 offen offset:2048 sc1 lds
    buffer_load_dwordx4 v2, s[4:7], s27 offen offset:3072 sc1 lds
    s_waitcnt vmcnt(28)
    s_barrier
    s_add_u32 s26, s25, 16384
    s_mov_b32 m0, s26
    s_add_u32 s27, s21, 98304
    buffer_load_dwordx4 v2, s[4:7], s27 offen offset:0 sc1 lds
    buffer_load_dwordx4 v2, s[4:7], s27 offen offset:1024 sc1 lds
    buffer_load_dwordx4 v2, s[4:7], s27 offen offset:2048 sc1 lds
    buffer_load_dwordx4 v2, s[4:7], s27 offen offset:3072 sc1 lds
    s_waitcnt vmcnt(28)
    s_barrier
    s_add_u32 s26, s25, 32768
    s_mov_b32 m0, s26
    s_add_u32 s27, s21, 114688
    buffer_load_dwordx4 v2, s[4:7], s27 offen offset:0 sc1 lds
    buffer_load_dwordx4 v2, s[4:7], s27 offen offset:1024 sc1 lds
    buffer_load_dwordx4 v2, s[4:7], s27 offen offset:2048 sc1 lds
    buffer_load_dwordx4 v2, s[4:7], s27 offen offset:3072 sc1 lds
    s_waitcnt vmcnt(24)
    s_barrier
    s_add_u32 s26, s25, 49152
    s_mov_b32 m0, s26
    s_add_u32 s27, s21, 131072
    buffer_load_dwordx4 v2, s[4:7], s27 offen offset:0 sc1 lds
    buffer_load_dwordx4 v2, s[4:7], s27 offen offset:1024 sc1 lds
    buffer_load_dwordx4 v2, s[4:7], s27 offen offset:2048 sc1 lds
    buffer_load_dwordx4 v2, s[4:7], s27 offen offset:3072 sc1 lds
    s_waitcnt vmcnt(20)
    s_barrier
    ds_write_b128 v17, v[176:179] offset:0
    s_waitcnt lgkmcnt(0)
    ds_write_b128 v17, v[180:183] offset:1024
    s_waitcnt lgkmcnt(0)
    ds_write_b128 v17, v[184:187] offset:2048
    s_waitcnt lgkmcnt(0)
    ds_write_b128 v17, v[188:191] offset:3072
    s_waitcnt lgkmcnt(0)
    s_waitcnt vmcnt(16)
    s_barrier
    ds_write_b128 v17, v[192:195] offset:16384
    s_waitcnt lgkmcnt(0)
    ds_write_b128 v17, v[196:199] offset:17408
    s_waitcnt lgkmcnt(0)
    ds_write_b128 v17, v[200:203] offset:18432
    s_waitcnt lgkmcnt(0)
    ds_write_b128 v17, v[204:207] offset:19456
    s_waitcnt lgkmcnt(0)
    s_waitcnt vmcnt(8)
    s_barrier
    ds_write_b128 v17, v[208:211] offset:32768
    s_waitcnt lgkmcnt(0)
    ds_write_b128 v17, v[212:215] offset:33792
    s_waitcnt lgkmcnt(0)
    ds_write_b128 v17, v[216:219] offset:34816
    s_waitcnt lgkmcnt(0)
    ds_write_b128 v17, v[220:223] offset:35840
    s_waitcnt lgkmcnt(0)
    s_waitcnt vmcnt(4)
    s_barrier
    ds_write_b128 v17, v[224:227] offset:49152
    s_waitcnt lgkmcnt(0)
    ds_write_b128 v17, v[228:231] offset:50176
    s_waitcnt lgkmcnt(0)
    ds_write_b128 v17, v[232:235] offset:51200
    s_waitcnt lgkmcnt(0)
    ds_write_b128 v17, v[236:239] offset:52224
    s_waitcnt lgkmcnt(0)
    s_waitcnt vmcnt(0) lgkmcnt(0)
    s_barrier
    ds_write_b128 v18, v[240:243] offset:0
    s_waitcnt lgkmcnt(0)
    ds_write_b128 v18, v[244:247] offset:1024
    s_waitcnt lgkmcnt(0)
    ds_write_b128 v18, v[248:251] offset:2048
    s_waitcnt lgkmcnt(0)
    ds_write_b128 v18, v[252:255] offset:3072
    s_waitcnt lgkmcnt(0)
    s_barrier
    s_mov_b64 exec, 1
    global_load_dword v14, v2, s[70:71] sc1
    s_mov_b64 exec, -1
    s_waitcnt lgkmcnt(0)
    s_barrier
    s_barrier
    s_barrier
    s_branch L_mlp_end_55
L_mlp_comp_54:
    s_add_u32 s31, s68, s16
    s_lshl_b32 s22, s31, 15
    s_add_u32 s22, s22, s41
    s_add_u32 s22, s22, 0x800000
    s_mul_i32 s26, s31, 114688
    s_add_u32 s26, s26, s41
    s_add_u32 s26, s26, 0xc00000
    s_mul_i32 s34, s69, 4096
    s_add_u32 s34, s34, s26
    s_mul_i32 s35, s69, 2048
    s_add_u32 s35, s35, s26
    s_add_u32 s35, s35, 65536
    s_mul_i32 s32, s69, 1024
    s_add_u32 s32, s32, s26
    s_add_u32 s32, s32, 98304
    s_lshl_b32 s50, s31, 8
    s_add_u32 s50, s50, s42
    s_add_u32 s23, s50, 0x8004
    s_add_u32 s50, s50, 0x4000
    s_and_b32 s24, s16, 1
    s_lshr_b32 s25, s16, 1
    s_lshl_b32 s33, s44, 1
    s_add_u32 s33, s33, s25
    s_add_u32 s31, s43, s24
    s_lshl_b32 s52, s31, 8
    s_add_u32 s52, s52, s42
    s_add_u32 s52, s52, 0x4000
    s_mul_i32 s37, s31, 114688
    s_lshl_b32 s30, s25, 11
    s_add_u32 s37, s37, s30
    s_add_u32 s37, s37, s41
    s_add_u32 s37, s37, 0xc00000
    s_mul_i32 s29, s25, 6144
    s_add_u32 s30, s30, 2048
    v_add_u32 v16, 0, v2
    v_add_u32 v30, s29, v16
    v_add_u32 v33, s30, v16
    v_add_u32 v17, 65536, v2
    v_add_u32 v31, s29, v17
    v_add_u32 v34, s30, v17
    v_add_u32 v18, 131072, v2
    v_add_u32 v32, s29, v18
    v_add_u32 v35, s30, v18
    v_lshrrev_b32 v29, 5, v0
    v_and_b32 v28, 0x3ff, v15
    v_lshl_add_u32 v28, v29, 8, v28
    v_and_b32 v29, 0xff, v2
    s_lshl_b32 s26, s16, 12
    v_add_u32 v29, s26, v29
    v_mov_b32 v24, 0
    v_mov_b32 v25, 0
    s_waitcnt vmcnt(0)
    s_mov_b32 s38, 1
    s_atomic_add s38, s[14:15], s48
    s_mov_b32 s39, 1048576
L_poll_56:
    s_mov_b32 s49, 0
    s_atomic_add s49, s[14:15], s23 glc
    s_sub_u32 s39, s39, 1
    s_waitcnt lgkmcnt(0)
    s_cmp_ge_u32 s49, 16
    s_cbranch_scc1 L_pok_57
    s_sleep 1
    s_cmp_lg_u32 s39, 0
    s_cbranch_scc1 L_poll_56
L_pok_57:
    s_setprio 2
    buffer_load_dwordx4 v[128:131], v15, s[4:7], s22 offen offset:0 sc1
    buffer_load_dwordx4 v[132:135], v15, s[4:7], s22 offen offset:256 sc1
    buffer_load_dwordx4 v[136:139], v15, s[4:7], s22 offen offset:2048 sc1
    buffer_load_dwordx4 v[140:143], v15, s[4:7], s22 offen offset:2304 sc1
    s_add_u32 s22, s22, 4096
    s_barrier
    ds_read_b128 v[100:103], v16 offset:0
    ds_read_b128 v[104:107], v16 offset:1024
    ds_read_b128 v[108:111], v16 offset:2048
    ds_read_b128 v[112:115], v16 offset:3072
    ds_read_b128 v[116:119], v16 offset:4096
    ds_read_b128 v[120:123], v16 offset:5120
    buffer_load_dwordx4 v[144:147], v15, s[4:7], s22 offen offset:0 sc1
    buffer_load_dwordx4 v[148:151], v15, s[4:7], s22 offen offset:256 sc1
    buffer_load_dwordx4 v[152:155], v15, s[4:7], s22 offen offset:2048 sc1
    buffer_load_dwordx4 v[156:159], v15, s[4:7], s22 offen offset:2304 sc1
    s_add_u32 s22, s22, 4096
    buffer_load_dwordx4 v[160:163], v15, s[4:7], s22 offen offset:0 sc1
    buffer_load_dwordx4 v[164:167], v15, s[4:7], s22 offen offset:256 sc1
    s_add_u32 s48, s52, 0x4008
    s_waitcnt lgkmcnt(4)
    s_waitcnt vmcnt(8)
    v_mfma_f32_16x16x32_bf16 v[36:39], v[100:103], v[128:131], 0
    ds_read_b128 v[124:127], v16 offset:6144
    v_mfma_f32_16x16x32_bf16 v[40:43], v[100:103], v[132:135], 0
    v_mfma_f32_16x16x32_bf16 v[44:47], v[104:107], v[128:131], 0
    ds_read_b128 v[100:103], v16 offset:7168
    v_mfma_f32_16x16x32_bf16 v[48:51], v[104:107], v[132:135], 0
    s_waitcnt lgkmcnt(4)
    v_mfma_f32_16x16x32_bf16 v[52:55], v[108:111], v[128:131], 0
    ds_read_b128 v[104:107], v16 offset:8192
    v_mfma_f32_16x16x32_bf16 v[56:59], v[108:111], v[132:135], 0
    v_mfma_f32_16x16x32_bf16 v[60:63], v[112:115], v[128:131], 0
    ds_read_b128 v[108:111], v16 offset:9216
    v_mfma_f32_16x16x32_bf16 v[64:67], v[112:115], v[132:135], 0
    buffer_load_dwordx4 v[168:171], v15, s[4:7], s22 offen offset:2048 sc1
    s_waitcnt lgkmcnt(4)
    v_mfma_f32_16x16x32_bf16 v[68:71], v[116:119], v[128:131], 0
    ds_read_b128 v[112:115], v16 offset:10240
    v_mfma_f32_16x16x32_bf16 v[72:75], v[116:119], v[132:135], 0
    v_mfma_f32_16x16x32_bf16 v[76:79], v[120:123], v[128:131], 0
    ds_read_b128 v[116:119], v16 offset:11264
    v_mfma_f32_16x16x32_bf16 v[80:83], v[120:123], v[132:135], 0
    s_waitcnt lgkmcnt(4)
    v_mfma_f32_16x16x32_bf16 v[84:87], v[124:127], v[128:131], 0
    ds_read_b128 v[120:123], v16 offset:12288
    v_mfma_f32_16x16x32_bf16 v[88:91], v[124:127], v[132:135], 0
    v_mfma_f32_16x16x32_bf16 v[92:95], v[100:103], v[128:131], 0
    ds_read_b128 v[124:127], v16 offset:13312
    v_mfma_f32_16x16x32_bf16 v[96:99], v[100:103], v[132:135], 0
    buffer_load_dwordx4 v[172:175], v15, s[4:7], s22 offen offset:2304 sc1
    s_add_u32 s22, s22, 4096
    s_waitcnt lgkmcnt(4)
    s_waitcnt vmcnt(8)
    v_mfma_f32_16x16x32_bf16 v[36:39], v[104:107], v[136:139], v[36:39]
    ds_read_b128 v[100:103], v16 offset:14336
    v_mfma_f32_16x16x32_bf16 v[40:43], v[104:107], v[140:143], v[40:43]
    v_mfma_f32_16x16x32_bf16 v[44:47], v[108:111], v[136:139], v[44:47]
    ds_read_b128 v[104:107], v16 offset:15360
    v_mfma_f32_16x16x32_bf16 v[48:51], v[108:111], v[140:143], v[48:51]
    s_waitcnt lgkmcnt(4)
    v_mfma_f32_16x16x32_bf16 v[52:55], v[112:115], v[136:139], v[52:55]
    ds_read_b128 v[108:111], v16 offset:16384
    v_mfma_f32_16x16x32_bf16 v[56:59], v[112:115], v[140:143], v[56:59]
    v_mfma_f32_16x16x32_bf16 v[60:63], v[116:119], v[136:139], v[60:63]
    ds_read_b128 v[112:115], v16 offset:17408
    v_mfma_f32_16x16x32_bf16 v[64:67], v[116:119], v[140:143], v[64:67]
    buffer_load_dwordx4 v[176:179], v15, s[4:7], s22 offen offset:0 sc1
    s_waitcnt lgkmcnt(4)
    v_mfma_f32_16x16x32_bf16 v[68:71], v[120:123], v[136:139], v[68:71]
    ds_read_b128 v[116:119], v16 offset:18432
    v_mfma_f32_16x16x32_bf16 v[72:75], v[120:123], v[140:143], v[72:75]
    v_mfma_f32_16x16x32_bf16 v[76:79], v[124:127], v[136:139], v[76:79]
    ds_read_b128 v[120:123], v16 offset:19456
    v_mfma_f32_16x16x32_bf16 v[80:83], v[124:127], v[140:143], v[80:83]
    s_waitcnt lgkmcnt(4)
    v_mfma_f32_16x16x32_bf16 v[84:87], v[100:103], v[136:139], v[84:87]
    ds_read_b128 v[124:127], v16 offset:20480
    v_mfma_f32_16x16x32_bf16 v[88:91], v[100:103], v[140:143], v[88:91]
    v_mfma_f32_16x16x32_bf16 v[92:95], v[104:107], v[136:139], v[92:95]
    ds_read_b128 v[100:103], v16 offset:21504
    v_mfma_f32_16x16x32_bf16 v[96:99], v[104:107], v[140:143], v[96:99]
    buffer_load_dwordx4 v[180:183], v15, s[4:7], s22 offen offset:256 sc1
    s_waitcnt lgkmcnt(4)
    s_waitcnt vmcnt(8)
    v_mfma_f32_16x16x32_bf16 v[36:39], v[108:111], v[144:147], v[36:39]
    ds_read_b128 v[104:107], v16 offset:22528
    v_mfma_f32_16x16x32_bf16 v[40:43], v[108:111], v[148:151], v[40:43]
    v_mfma_f32_16x16x32_bf16 v[44:47], v[112:115], v[144:147], v[44:47]
    ds_read_b128 v[108:111], v16 offset:23552
    v_mfma_f32_16x16x32_bf16 v[48:51], v[112:115], v[148:151], v[48:51]
    s_waitcnt lgkmcnt(4)
    v_mfma_f32_16x16x32_bf16 v[52:55], v[116:119], v[144:147], v[52:55]
    ds_read_b128 v[112:115], v16 offset:24576
    v_mfma_f32_16x16x32_bf16 v[56:59], v[116:119], v[148:151], v[56:59]
    v_mfma_f32_16x16x32_bf16 v[60:63], v[120:123], v[144:147], v[60:63]
    ds_read_b128 v[116:119], v16 offset:25600
    v_mfma_f32_16x16x32_bf16 v[64:67], v[120:123], v[148:151], v[64:67]
    buffer_load_dwordx4 v[184:187], v15, s[4:7], s22 offen offset:2048 sc1
    s_barrier
    s_waitcnt lgkmcnt(4)
    v_mfma_f32_16x16x32_bf16 v[68:71], v[124:127], v[144:147], v[68:71]
    ds_read_b128 v[120:123], v16 offset:26624
    v_mfma_f32_16x16x32_bf16 v[72:75], v[124:127], v[148:151], v[72:75]
    v_mfma_f32_16x16x32_bf16 v[76:79], v[100:103], v[144:147], v[76:79]
    ds_read_b128 v[124:127], v16 offset:27648
    v_mfma_f32_16x16x32_bf16 v[80:83], v[100:103], v[148:151], v[80:83]
    s_waitcnt lgkmcnt(4)
    v_mfma_f32_16x16x32_bf16 v[84:87], v[104:107], v[144:147], v[84:87]
    ds_read_b128 v[100:103], v16 offset:28672
    v_mfma_f32_16x16x32_bf16 v[88:91], v[104:107], v[148:151], v[88:91]
    v_mfma_f32_16x16x32_bf16 v[92:95], v[108:111], v[144:147], v[92:95]
    ds_read_b128 v[104:107], v16 offset:29696
    v_mfma_f32_16x16x32_bf16 v[96:99], v[108:111], v[148:151], v[96:99]
    buffer_load_dwordx4 v[188:191], v15, s[4:7], s22 offen offset:2304 sc1
    s_add_u32 s22, s22, 4096
    s_waitcnt lgkmcnt(4)
    s_waitcnt vmcnt(8)
    v_mfma_f32_16x16x32_bf16 v[36:39], v[112:115], v[152:155], v[36:39]
    ds_read_b128 v[108:111], v16 offset:30720
    v_mfma_f32_16x16x32_bf16 v[40:43], v[112:115], v[156:159], v[40:43]
    v_mfma_f32_16x16x32_bf16 v[44:47], v[116:119], v[152:155], v[44:47]
    ds_read_b128 v[112:115], v16 offset:31744
    v_mfma_f32_16x16x32_bf16 v[48:51], v[116:119], v[156:159], v[48:51]
    s_waitcnt lgkmcnt(4)
    v_mfma_f32_16x16x32_bf16 v[52:55], v[120:123], v[152:155], v[52:55]
    ds_read_b128 v[116:119], v16 offset:32768
    v_mfma_f32_16x16x32_bf16 v[56:59], v[120:123], v[156:159], v[56:59]
    v_mfma_f32_16x16x32_bf16 v[60:63], v[124:127], v[152:155], v[60:63]
    ds_read_b128 v[120:123], v16 offset:33792
    v_mfma_f32_16x16x32_bf16 v[64:67], v[124:127], v[156:159], v[64:67]
    buffer_load_dwordx4 v[192:195], v15, s[4:7], s22 offen offset:0 sc1
    s_waitcnt lgkmcnt(4)
    v_mfma_f32_16x16x32_bf16 v[68:71], v[100:103], v[152:155], v[68:71]
    ds_read_b128 v[124:127], v16 offset:34816
    v_mfma_f32_16x16x32_bf16 v[72:75], v[100:103], v[156:159], v[72:75]
    v_mfma_f32_16x16x32_bf16 v[76:79], v[104:107], v[152:155], v[76:79]
    ds_read_b128 v[100:103], v16 offset:35840
    v_mfma_f32_16x16x32_bf16 v[80:83], v[104:107], v[156:159], v[80:83]
    s_waitcnt lgkmcnt(4)
    v_mfma_f32_16x16x32_bf16 v[84:87], v[108:111], v[152:155], v[84:87]
    ds_read_b128 v[104:107], v16 offset:36864
    v_mfma_f32_16x16x32_bf16 v[88:91], v[108:111], v[156:159], v[88:91]
    v_mfma_f32_16x16x32_bf16 v[92:95], v[112:115], v[152:155], v[92:95]
    ds_read_b128 v[108:111], v16 offset:37888
    v_mfma_f32_16x16x32_bf16 v[96:99], v[112:115], v[156:159], v[96:99]
    buffer_load_dwordx4 v[196:199], v15, s[4:7], s22 offen offset:256 sc1
    s_waitcnt lgkmcnt(4)
    s_waitcnt vmcnt(8)
    v_mfma_f32_16x16x32_bf16 v[36:39], v[116:119], v[160:163], v[36:39]
    ds_read_b128 v[112:115], v16 offset:38912
    v_mfma_f32_16x16x32_bf16 v[40:43], v[116:119], v[164:167], v[40:43]
    v_mfma_f32_16x16x32_bf16 v[44:47], v[120:123], v[160:163], v[44:47]
    ds_read_b128 v[116:119], v16 offset:39936
    v_mfma_f32_16x16x32_bf16 v[48:51], v[120:123], v[164:167], v[48:51]
    s_waitcnt lgkmcnt(4)
    v_mfma_f32_16x16x32_bf16 v[52:55], v[124:127], v[160:163], v[52:55]
    ds_read_b128 v[120:123], v16 offset:40960
    v_mfma_f32_16x16x32_bf16 v[56:59], v[124:127], v[164:167], v[56:59]
    v_mfma_f32_16x16x32_bf16 v[60:63], v[100:103], v[160:163], v[60:63]
    ds_read_b128 v[124:127], v16 offset:41984
    v_mfma_f32_16x16x32_bf16 v[64:67], v[100:103], v[164:167], v[64:67]
    buffer_load_dwordx4 v[200:203], v15, s[4:7], s22 offen offset:2048 sc1
    s_waitcnt lgkmcnt(4)
    v_mfma_f32_16x16x32_bf16 v[68:71], v[104:107], v[160:163], v[68:71]
    ds_read_b128 v[100:103], v16 offset:43008
    v_mfma_f32_16x16x32_bf16 v[72:75], v[104:107], v[164:167], v[72:75]
    v_mfma_f32_16x16x32_bf16 v[76:79], v[108:111], v[160:163], v[76:79]
    ds_read_b128 v[104:107], v16 offset:44032
    v_mfma_f32_16x16x32_bf16 v[80:83], v[108:111], v[164:167], v[80:83]
    s_waitcnt lgkmcnt(4)
    v_mfma_f32_16x16x32_bf16 v[84:87], v[112:115], v[160:163], v[84:87]
    ds_read_b128 v[108:111], v16 offset:45056
    v_mfma_f32_16x16x32_bf16 v[88:91], v[112:115], v[164:167], v[88:91]
    v_mfma_f32_16x16x32_bf16 v[92:95], v[116:119], v[160:163], v[92:95]
    ds_read_b128 v[112:115], v16 offset:46080
    v_mfma_f32_16x16x32_bf16 v[96:99], v[116:119], v[164:167], v[96:99]
    buffer_load_dwordx4 v[204:207], v15, s[4:7], s22 offen offset:2304 sc1
    s_add_u32 s22, s22, 4096
    s_barrier
    s_waitcnt lgkmcnt(4)
    s_waitcnt vmcnt(8)
    v_mfma_f32_16x16x32_bf16 v[36:39], v[120:123], v[168:171], v[36:39]
    ds_read_b128 v[116:119], v16 offset:47104
    v_mfma_f32_16x16x32_bf16 v[40:43], v[120:123], v[172:175], v[40:43]
    ds_read_b64 v[20:21], v29 offset:0
    v_mfma_f32_16x16x32_bf16 v[44:47], v[124:127], v[168:171], v[44:47]
    ds_read_b128 v[120:123], v16 offset:48128
    v_mfma_f32_16x16x32_bf16 v[48:51], v[124:127], v[172:175], v[48:51]
    ds_read_b32 v26, v29 offset:8
    s_waitcnt lgkmcnt(6)
    v_mfma_f32_16x16x32_bf16 v[52:55], v[100:103], v[168:171], v[52:55]
    ds_read_b128 v[124:127], v16 offset:49152
    v_mfma_f32_16x16x32_bf16 v[56:59], v[100:103], v[172:175], v[56:59]
    ds_read_b64 v[22:23], v29 offset:512
    v_mfma_f32_16x16x32_bf16 v[60:63], v[104:107], v[168:171], v[60:63]
    ds_read_b128 v[100:103], v16 offset:50176
    v_mfma_f32_16x16x32_bf16 v[64:67], v[104:107], v[172:175], v[64:67]
    buffer_load_dwordx4 v[208:211], v15, s[4:7], s22 offen offset:0 sc1
    ds_read_b32 v27, v29 offset:520
    s_waitcnt lgkmcnt(8)
    v_mfma_f32_16x16x32_bf16 v[68:71], v[108:111], v[168:171], v[68:71]
    ds_read_b128 v[104:107], v16 offset:51200
    v_mfma_f32_16x16x32_bf16 v[72:75], v[108:111], v[172:175], v[72:75]
    v_mfma_f32_16x16x32_bf16 v[76:79], v[112:115], v[168:171], v[76:79]
    ds_read_b128 v[108:111], v16 offset:52224
    v_mfma_f32_16x16x32_bf16 v[80:83], v[112:115], v[172:175], v[80:83]
    s_waitcnt lgkmcnt(7)
    v_mfma_f32_16x16x32_bf16 v[84:87], v[116:119], v[168:171], v[84:87]
    ds_read_b128 v[112:115], v16 offset:53248
    v_mfma_f32_16x16x32_bf16 v[88:91], v[116:119], v[172:175], v[88:91]
    v_mfma_f32_16x16x32_bf16 v[92:95], v[120:123], v[168:171], v[92:95]
    ds_read_b128 v[116:119], v16 offset:54272
    v_mfma_f32_16x16x32_bf16 v[96:99], v[120:123], v[172:175], v[96:99]
    buffer_load_dwordx4 v[212:215], v15, s[4:7], s22 offen offset:256 sc1
    s_waitcnt lgkmcnt(5)
    s_waitcnt vmcnt(8)
    v_mfma_f32_16x16x32_bf16 v[36:39], v[124:127], v[176:179], v[36:39]
    ds_read_b128 v[120:123], v16 offset:55296
    v_mfma_f32_16x16x32_bf16 v[40:43], v[124:127], v[180:183], v[40:43]
    v_mfma_f32_16x16x32_bf16 v[44:47], v[100:103], v[176:179], v[44:47]
    ds_read_b128 v[124:127], v16 offset:56320
    v_mfma_f32_16x16x32_bf16 v[48:51], v[100:103], v[180:183], v[48:51]
    s_waitcnt lgkmcnt(4)
    v_mfma_f32_16x16x32_bf16 v[52:55], v[104:107], v[176:179], v[52:55]
    ds_read_b128 v[100:103], v16 offset:57344
    v_mfma_f32_16x16x32_bf16 v[56:59], v[104:107], v[180:183], v[56:59]
    v_mfma_f32_16x16x32_bf16 v[60:63], v[108:111], v[176:179], v[60:63]
    ds_read_b128 v[104:107], v16 offset:58368
    v_mfma_f32_16x16x32_bf16 v[64:67], v[108:111], v[180:183], v[64:67]
    buffer_load_dwordx4 v[216:219], v15, s[4:7], s22 offen offset:2048 sc1
    s_waitcnt lgkmcnt(4)
    v_mfma_f32_16x16x32_bf16 v[68:71], v[112:115], v[176:179], v[68:71]
    ds_read_b128 v[108:111], v16 offset:59392
    v_mfma_f32_16x16x32_bf16 v[72:75], v[112:115], v[180:183], v[72:75]
    v_mfma_f32_16x16x32_bf16 v[76:79], v[116:119], v[176:179], v[76:79]
    ds_read_b128 v[112:115], v16 offset:60416
    v_mfma_f32_16x16x32_bf16 v[80:83], v[116:119], v[180:183], v[80:83]
    s_barrier
    s_waitcnt lgkmcnt(4)
    v_mfma_f32_16x16x32_bf16 v[84:87], v[120:123], v[176:179], v[84:87]
    ds_read_b128 v[116:119], v16 offset:61440
    v_mfma_f32_16x16x32_bf16 v[88:91], v[120:123], v[180:183], v[88:91]
    v_mfma_f32_16x16x32_bf16 v[92:95], v[124:127], v[176:179], v[92:95]
    ds_read_b128 v[120:123], v16 offset:62464
    v_mfma_f32_16x16x32_bf16 v[96:99], v[124:127], v[180:183], v[96:99]
    buffer_load_dwordx4 v[220:223], v15, s[4:7], s22 offen offset:2304 sc1
    s_add_u32 s22, s22, 4096
    s_waitcnt lgkmcnt(4)
    s_waitcnt vmcnt(8)
    v_mfma_f32_16x16x32_bf16 v[36:39], v[100:103], v[184:187], v[36:39]
    ds_read_b128 v[124:127], v16 offset:63488
    v_mfma_f32_16x16x32_bf16 v[40:43], v[100:103], v[188:191], v[40:43]
    v_mfma_f32_16x16x32_bf16 v[44:47], v[104:107], v[184:187], v[44:47]
    ds_read_b128 v[100:103], v16 offset:64512
    v_mfma_f32_16x16x32_bf16 v[48:51], v[104:107], v[188:191], v[48:51]
    s_waitcnt lgkmcnt(4)
    v_mfma_f32_16x16x32_bf16 v[52:55], v[108:111], v[184:187], v[52:55]
    ds_read_b128 v[104:107], v17 offset:0
    v_mfma_f32_16x16x32_bf16 v[56:59], v[108:111], v[188:191], v[56:59]
    v_mfma_f32_16x16x32_bf16 v[60:63], v[112:115], v[184:187], v[60:63]
    ds_read_b128 v[108:111], v17 offset:1024
    v_mfma_f32_16x16x32_bf16 v[64:67], v[112:115], v[188:191], v[64:67]
    buffer_load_dwordx4 v[224:227], v15, s[4:7], s22 offen offset:0 sc1
    s_waitcnt lgkmcnt(4)
    v_mfma_f32_16x16x32_bf16 v[68:71], v[116:119], v[184:187], v[68:71]
    ds_read_b128 v[112:115], v17 offset:2048
    v_mfma_f32_16x16x32_bf16 v[72:75], v[116:119], v[188:191], v[72:75]
    v_mfma_f32_16x16x32_bf16 v[76:79], v[120:123], v[184:187], v[76:79]
    ds_read_b128 v[116:119], v17 offset:3072
    v_mfma_f32_16x16x32_bf16 v[80:83], v[120:123], v[188:191], v[80:83]
    s_waitcnt lgkmcnt(4)
    v_mfma_f32_16x16x32_bf16 v[84:87], v[124:127], v[184:187], v[84:87]
    ds_read_b128 v[120:123], v17 offset:4096
    v_mfma_f32_16x16x32_bf16 v[88:91], v[124:127], v[188:191], v[88:91]
    v_mfma_f32_16x16x32_bf16 v[92:95], v[100:103], v[184:187], v[92:95]
    ds_read_b128 v[124:127], v17 offset:5120
    v_mfma_f32_16x16x32_bf16 v[96:99], v[100:103], v[188:191], v[96:99]
    buffer_load_dwordx4 v[228:231], v15, s[4:7], s22 offen offset:256 sc1
    s_waitcnt lgkmcnt(4)
    s_waitcnt vmcnt(8)
    v_mfma_f32_16x16x32_bf16 v[36:39], v[104:107], v[192:195], v[36:39]
    ds_read_b128 v[100:103], v17 offset:6144
    v_mfma_f32_16x16x32_bf16 v[40:43], v[104:107], v[196:199], v[40:43]
    v_mfma_f32_16x16x32_bf16 v[44:47], v[108:111], v[192:195], v[44:47]
    ds_read_b128 v[104:107], v17 offset:7168
    v_mfma_f32_16x16x32_bf16 v[48:51], v[108:111], v[196:199], v[48:51]
    s_waitcnt lgkmcnt(4)
    v_mfma_f32_16x16x32_bf16 v[52:55], v[112:115], v[192:195], v[52:55]
    ds_read_b128 v[108:111], v17 offset:8192
    v_mfma_f32_16x16x32_bf16 v[56:59], v[112:115], v[196:199], v[56:59]
    v_mfma_f32_16x16x32_bf16 v[60:63], v[116:119], v[192:195], v[60:63]
    ds_read_b128 v[112:115], v17 offset:9216
    v_mfma_f32_16x16x32_bf16 v[64:67], v[116:119], v[196:199], v[64:67]
    buffer_load_dwordx4 v[232:235], v15, s[4:7], s22 offen offset:2048 sc1
    s_barrier
    s_waitcnt lgkmcnt(4)
    v_mfma_f32_16x16x32_bf16 v[68:71], v[120:123], v[192:195], v[68:71]
    ds_read_b128 v[116:119], v17 offset:10240
    v_mfma_f32_16x16x32_bf16 v[72:75], v[120:123], v[196:199], v[72:75]
    v_mfma_f32_16x16x32_bf16 v[76:79], v[124:127], v[192:195], v[76:79]
    ds_read_b128 v[120:123], v17 offset:11264
    v_mfma_f32_16x16x32_bf16 v[80:83], v[124:127], v[196:199], v[80:83]
    s_waitcnt lgkmcnt(4)
    v_mfma_f32_16x16x32_bf16 v[84:87], v[100:103], v[192:195], v[84:87]
    ds_read_b128 v[124:127], v17 offset:12288
    v_mfma_f32_16x16x32_bf16 v[88:91], v[100:103], v[196:199], v[88:91]
    v_mfma_f32_16x16x32_bf16 v[92:95], v[104:107], v[192:195], v[92:95]
    ds_read_b128 v[100:103], v17 offset:13312
    v_mfma_f32_16x16x32_bf16 v[96:99], v[104:107], v[196:199], v[96:99]
    buffer_load_dwordx4 v[236:239], v15, s[4:7], s22 offen offset:2304 sc1
    s_add_u32 s22, s22, 4096
    s_waitcnt lgkmcnt(4)
    s_waitcnt vmcnt(8)
    v_mfma_f32_16x16x32_bf16 v[36:39], v[108:111], v[200:203], v[36:39]
    ds_read_b128 v[104:107], v17 offset:14336
    v_mfma_f32_16x16x32_bf16 v[40:43], v[108:111], v[204:207], v[40:43]
    v_mfma_f32_16x16x32_bf16 v[44:47], v[112:115], v[200:203], v[44:47]
    ds_read_b128 v[108:111], v17 offset:15360
    v_mfma_f32_16x16x32_bf16 v[48:51], v[112:115], v[204:207], v[48:51]
    s_waitcnt lgkmcnt(4)
    v_mfma_f32_16x16x32_bf16 v[52:55], v[116:119], v[200:203], v[52:55]
    ds_read_b128 v[112:115], v17 offset:16384
    v_mfma_f32_16x16x32_bf16 v[56:59], v[116:119], v[204:207], v[56:59]
    v_mfma_f32_16x16x32_bf16 v[60:63], v[120:123], v[200:203], v[60:63]
    ds_read_b128 v[116:119], v17 offset:17408
    v_mfma_f32_16x16x32_bf16 v[64:67], v[120:123], v[204:207], v[64:67]
    buffer_load_dwordx4 v[240:243], v15, s[4:7], s22 offen offset:0 sc1
    s_waitcnt lgkmcnt(4)
    v_mfma_f32_16x16x32_bf16 v[68:71], v[124:127], v[200:203], v[68:71]
    ds_read_b128 v[120:123], v17 offset:18432
    v_mfma_f32_16x16x32_bf16 v[72:75], v[124:127], v[204:207], v[72:75]
    v_mfma_f32_16x16x32_bf16 v[76:79], v[100:103], v[200:203], v[76:79]
    ds_read_b128 v[124:127], v17 offset:19456
    v_mfma_f32_16x16x32_bf16 v[80:83], v[100:103], v[204:207], v[80:83]
    s_waitcnt lgkmcnt(4)
    v_mfma_f32_16x16x32_bf16 v[84:87], v[104:107], v[200:203], v[84:87]
    ds_read_b128 v[100:103], v17 offset:20480
    v_mfma_f32_16x16x32_bf16 v[88:91], v[104:107], v[204:207], v[88:91]
    v_mfma_f32_16x16x32_bf16 v[92:95], v[108:111], v[200:203], v[92:95]
    ds_read_b128 v[104:107], v17 offset:21504
    v_mfma_f32_16x16x32_bf16 v[96:99], v[108:111], v[204:207], v[96:99]
    buffer_load_dwordx4 v[244:247], v15, s[4:7], s22 offen offset:256 sc1
    s_waitcnt lgkmcnt(4)
    s_waitcnt vmcnt(8)
    v_mfma_f32_16x16x32_bf16 v[36:39], v[112:115], v[208:211], v[36:39]
    ds_read_b128 v[108:111], v17 offset:22528
    v_mfma_f32_16x16x32_bf16 v[40:43], v[112:115], v[212:215], v[40:43]
    v_mfma_f32_16x16x32_bf16 v[44:47], v[116:119], v[208:211], v[44:47]
    ds_read_b128 v[112:115], v17 offset:23552
    v_mfma_f32_16x16x32_bf16 v[48:51], v[116:119], v[212:215], v[48:51]
    s_barrier
    s_waitcnt lgkmcnt(4)
    v_mfma_f32_16x16x32_bf16 v[52:55], v[120:123], v[208:211], v[52:55]
    ds_read_b128 v[116:119], v17 offset:24576
    v_mfma_f32_16x16x32_bf16 v[56:59], v[120:123], v[212:215], v[56:59]
    v_mfma_f32_16x16x32_bf16 v[60:63], v[124:127], v[208:211], v[60:63]
    ds_read_b128 v[120:123], v17 offset:25600
    v_mfma_f32_16x16x32_bf16 v[64:67], v[124:127], v[212:215], v[64:67]
    buffer_load_dwordx4 v[248:251], v15, s[4:7], s22 offen offset:2048 sc1
    s_waitcnt lgkmcnt(4)
    v_mfma_f32_16x16x32_bf16 v[68:71], v[100:103], v[208:211], v[68:71]
    ds_read_b128 v[124:127], v17 offset:26624
    v_mfma_f32_16x16x32_bf16 v[72:75], v[100:103], v[212:215], v[72:75]
    v_mfma_f32_16x16x32_bf16 v[76:79], v[104:107], v[208:211], v[76:79]
    ds_read_b128 v[100:103], v17 offset:27648
    v_mfma_f32_16x16x32_bf16 v[80:83], v[104:107], v[212:215], v[80:83]
    s_waitcnt lgkmcnt(4)
    v_mfma_f32_16x16x32_bf16 v[84:87], v[108:111], v[208:211], v[84:87]
    ds_read_b128 v[104:107], v17 offset:28672
    v_mfma_f32_16x16x32_bf16 v[88:91], v[108:111], v[212:215], v[88:91]
    v_mfma_f32_16x16x32_bf16 v[92:95], v[112:115], v[208:211], v[92:95]
    ds_read_b128 v[108:111], v17 offset:29696
    v_mfma_f32_16x16x32_bf16 v[96:99], v[112:115], v[212:215], v[96:99]
    buffer_load_dwordx4 v[252:255], v15, s[4:7], s22 offen offset:2304 sc1
    s_add_u32 s22, s22, 4096
    s_waitcnt lgkmcnt(4)
    s_waitcnt vmcnt(8)
    v_mfma_f32_16x16x32_bf16 v[36:39], v[116:119], v[216:219], v[36:39]
    ds_read_b128 v[112:115], v17 offset:30720
    v_mfma_f32_16x16x32_bf16 v[40:43], v[116:119], v[220:223], v[40:43]
    v_mfma_f32_16x16x32_bf16 v[44:47], v[120:123], v[216:219], v[44:47]
    ds_read_b128 v[116:119], v17 offset:31744
    v_mfma_f32_16x16x32_bf16 v[48:51], v[120:123], v[220:223], v[48:51]
    s_waitcnt lgkmcnt(4)
    v_mfma_f32_16x16x32_bf16 v[52:55], v[124:127], v[216:219], v[52:55]
    ds_read_b128 v[120:123], v17 offset:32768
    v_mfma_f32_16x16x32_bf16 v[56:59], v[124:127], v[220:223], v[56:59]
    v_mfma_f32_16x16x32_bf16 v[60:63], v[100:103], v[216:219], v[60:63]
    ds_read_b128 v[124:127], v17 offset:33792
    v_mfma_f32_16x16x32_bf16 v[64:67], v[100:103], v[220:223], v[64:67]
    s_waitcnt lgkmcnt(4)
    v_mfma_f32_16x16x32_bf16 v[68:71], v[104:107], v[216:219], v[68:71]
    ds_read_b128 v[100:103], v17 offset:34816
    v_mfma_f32_16x16x32_bf16 v[72:75], v[104:107], v[220:223], v[72:75]
    v_mfma_f32_16x16x32_bf16 v[76:79], v[108:111], v[216:219], v[76:79]
    ds_read_b128 v[104:107], v17 offset:35840
    v_mfma_f32_16x16x32_bf16 v[80:83], v[108:111], v[220:223], v[80:83]
    s_waitcnt lgkmcnt(4)
    v_mfma_f32_16x16x32_bf16 v[84:87], v[112:115], v[216:219], v[84:87]
    ds_read_b128 v[108:111], v17 offset:36864
    v_mfma_f32_16x16x32_bf16 v[88:91], v[112:115], v[220:223], v[88:91]
    v_mfma_f32_16x16x32_bf16 v[92:95], v[116:119], v[216:219], v[92:95]
    ds_read_b128 v[112:115], v17 offset:37888
    v_mfma_f32_16x16x32_bf16 v[96:99], v[116:119], v[220:223], v[96:99]
    s_barrier
    s_waitcnt lgkmcnt(4)
    s_waitcnt vmcnt(6)
    v_mfma_f32_16x16x32_bf16 v[36:39], v[120:123], v[224:227], v[36:39]
    ds_read_b128 v[116:119], v17 offset:38912
    v_mfma_f32_16x16x32_bf16 v[40:43], v[120:123], v[228:231], v[40:43]
    v_mfma_f32_16x16x32_bf16 v[44:47], v[124:127], v[224:227], v[44:47]
    ds_read_b128 v[120:123], v17 offset:39936
    v_mfma_f32_16x16x32_bf16 v[48:51], v[124:127], v[228:231], v[48:51]
    s_waitcnt lgkmcnt(4)
    v_mfma_f32_16x16x32_bf16 v[52:55], v[100:103], v[224:227], v[52:55]
    ds_read_b128 v[124:127], v17 offset:40960
    v_mfma_f32_16x16x32_bf16 v[56:59], v[100:103], v[228:231], v[56:59]
    v_mfma_f32_16x16x32_bf16 v[60:63], v[104:107], v[224:227], v[60:63]
    ds_read_b128 v[100:103], v17 offset:41984
    v_mfma_f32_16x16x32_bf16 v[64:67], v[104:107], v[228:231], v[64:67]
    s_waitcnt lgkmcnt(4)
    v_mfma_f32_16x16x32_bf16 v[68:71], v[108:111], v[224:227], v[68:71]
    ds_read_b128 v[104:107], v17 offset:43008
    v_mfma_f32_16x16x32_bf16 v[72:75], v[108:111], v[228:231], v[72:75]
    v_mfma_f32_16x16x32_bf16 v[76:79], v[112:115], v[224:227], v[76:79]
    ds_read_b128 v[108:111], v17 offset:44032
    v_mfma_f32_16x16x32_bf16 v[80:83], v[112:115], v[228:231], v[80:83]
    s_waitcnt lgkmcnt(4)
    v_mfma_f32_16x16x32_bf16 v[84:87], v[116:119], v[224:227], v[84:87]
    ds_read_b128 v[112:115], v17 offset:45056
    v_mfma_f32_16x16x32_bf16 v[88:91], v[116:119], v[228:231], v[88:91]
    v_mfma_f32_16x16x32_bf16 v[92:95], v[120:123], v[224:227], v[92:95]
    ds_read_b128 v[116:119], v17 offset:46080
    v_mfma_f32_16x16x32_bf16 v[96:99], v[120:123], v[228:231], v[96:99]
    s_waitcnt lgkmcnt(4)
    s_waitcnt vmcnt(4)
    v_mfma_f32_16x16x32_bf16 v[36:39], v[124:127], v[232:235], v[36:39]
    ds_read_b128 v[120:123], v17 offset:47104
    v_mfma_f32_16x16x32_bf16 v[40:43], v[124:127], v[236:239], v[40:43]
    v_mfma_f32_16x16x32_bf16 v[44:47], v[100:103], v[232:235], v[44:47]
    ds_read_b128 v[124:127], v17 offset:48128
    v_mfma_f32_16x16x32_bf16 v[48:51], v[100:103], v[236:239], v[48:51]
    s_waitcnt lgkmcnt(4)
    v_mfma_f32_16x16x32_bf16 v[52:55], v[104:107], v[232:235], v[52:55]
    ds_read_b128 v[100:103], v17 offset:49152
    v_mfma_f32_16x16x32_bf16 v[56:59], v[104:107], v[236:239], v[56:59]
    v_mfma_f32_16x16x32_bf16 v[60:63], v[108:111], v[232:235], v[60:63]
    ds_read_b128 v[104:107], v17 offset:50176
    v_mfma_f32_16x16x32_bf16 v[64:67], v[108:111], v[236:239], v[64:67]
    s_waitcnt lgkmcnt(4)
    v_mfma_f32_16x16x32_bf16 v[68:71], v[112:115], v[232:235], v[68:71]
    ds_read_b128 v[108:111], v17 offset:51200
    v_mfma_f32_16x16x32_bf16 v[72:75], v[112:115], v[236:239], v[72:75]
    v_mfma_f32_16x16x32_bf16 v[76:79], v[116:119], v[232:235], v[76:79]
    ds_read_b128 v[112:115], v17 offset:52224
    v_mfma_f32_16x16x32_bf16 v[80:83], v[116:119], v[236:239], v[80:83]
    s_waitcnt lgkmcnt(4)
    v_mfma_f32_16x16x32_bf16 v[84:87], v[120:123], v[232:235], v[84:87]
    ds_read_b128 v[116:119], v17 offset:53248
    v_mfma_f32_16x16x32_bf16 v[88:91], v[120:123], v[236:239], v[88:91]
    v_mfma_f32_16x16x32_bf16 v[92:95], v[124:127], v[232:235], v[92:95]
    ds_read_b128 v[120:123], v17 offset:54272
    v_mfma_f32_16x16x32_bf16 v[96:99], v[124:127], v[236:239], v[96:99]
    s_waitcnt lgkmcnt(4)
    s_waitcnt vmcnt(2)
    v_mfma_f32_16x16x32_bf16 v[36:39], v[100:103], v[240:243], v[36:39]
    ds_read_b128 v[124:127], v17 offset:55296
    v_mfma_f32_16x16x32_bf16 v[40:43], v[100:103], v[244:247], v[40:43]
    v_mfma_f32_16x16x32_bf16 v[44:47], v[104:107], v[240:243], v[44:47]
    ds_read_b128 v[100:103], v17 offset:56320
    v_mfma_f32_16x16x32_bf16 v[48:51], v[104:107], v[244:247], v[48:51]
    s_waitcnt lgkmcnt(4)
    v_mfma_f32_16x16x32_bf16 v[52:55], v[108:111], v[240:243], v[52:55]
    ds_read_b128 v[104:107], v17 offset:57344
    v_mfma_f32_16x16x32_bf16 v[56:59], v[108:111], v[244:247], v[56:59]
    v_mfma_f32_16x16x32_bf16 v[60:63], v[112:115], v[240:243], v[60:63]
    ds_read_b128 v[108:111], v17 offset:58368
    v_mfma_f32_16x16x32_bf16 v[64:67], v[112:115], v[244:247], v[64:67]
    s_waitcnt lgkmcnt(4)
    v_mfma_f32_16x16x32_bf16 v[68:71], v[116:119], v[240:243], v[68:71]
    ds_read_b128 v[112:115], v17 offset:59392
    v_mfma_f32_16x16x32_bf16 v[72:75], v[116:119], v[244:247], v[72:75]
    v_mfma_f32_16x16x32_bf16 v[76:79], v[120:123], v[240:243], v[76:79]
    ds_read_b128 v[116:119], v17 offset:60416
    v_mfma_f32_16x16x32_bf16 v[80:83], v[120:123], v[244:247], v[80:83]
    s_waitcnt lgkmcnt(4)
    v_mfma_f32_16x16x32_bf16 v[84:87], v[124:127], v[240:243], v[84:87]
    ds_read_b128 v[120:123], v17 offset:61440
    v_mfma_f32_16x16x32_bf16 v[88:91], v[124:127], v[244:247], v[88:91]
    v_mfma_f32_16x16x32_bf16 v[92:95], v[100:103], v[240:243], v[92:95]
    ds_read_b128 v[124:127], v17 offset:62464
    v_mfma_f32_16x16x32_bf16 v[96:99], v[100:103], v[244:247], v[96:99]
    s_barrier
    s_waitcnt lgkmcnt(4)
    s_waitcnt vmcnt(0)
    v_mfma_f32_16x16x32_bf16 v[36:39], v[104:107], v[248:251], v[36:39]
    ds_read_b128 v[100:103], v17 offset:63488
    v_mfma_f32_16x16x32_bf16 v[40:43], v[104:107], v[252:255], v[40:43]
    v_mfma_f32_16x16x32_bf16 v[44:47], v[108:111], v[248:251], v[44:47]
    ds_read_b128 v[104:107], v17 offset:64512
    v_mfma_f32_16x16x32_bf16 v[48:51], v[108:111], v[252:255], v[48:51]
    s_waitcnt lgkmcnt(4)
    v_mfma_f32_16x16x32_bf16 v[52:55], v[112:115], v[248:251], v[52:55]
    ds_read_b128 v[108:111], v18 offset:0
    v_mfma_f32_16x16x32_bf16 v[56:59], v[112:115], v[252:255], v[56:59]
    v_mfma_f32_16x16x32_bf16 v[60:63], v[116:119], v[248:251], v[60:63]
    ds_read_b128 v[112:115], v18 offset:1024
    v_mfma_f32_16x16x32_bf16 v[64:67], v[116:119], v[252:255], v[64:67]
    s_waitcnt lgkmcnt(4)
    v_mfma_f32_16x16x32_bf16 v[68:71], v[120:123], v[248:251], v[68:71]
    ds_read_b128 v[116:119], v18 offset:2048
    v_mfma_f32_16x16x32_bf16 v[72:75], v[120:123], v[252:255], v[72:75]
    v_mfma_f32_16x16x32_bf16 v[76:79], v[124:127], v[248:251], v[76:79]
    ds_read_b128 v[120:123], v18 offset:3072
    v_mfma_f32_16x16x32_bf16 v[80:83], v[124:127], v[252:255], v[80:83]
    s_waitcnt lgkmcnt(4)
    v_mfma_f32_16x16x32_bf16 v[84:87], v[100:103], v[248:251], v[84:87]
    ds_read_b128 v[124:127], v18 offset:4096
    v_mfma_f32_16x16x32_bf16 v[88:91], v[100:103], v[252:255], v[88:91]
    v_mfma_f32_16x16x32_bf16 v[92:95], v[104:107], v[248:251], v[92:95]
    ds_read_b128 v[100:103], v18 offset:5120
    v_mfma_f32_16x16x32_bf16 v[96:99], v[104:107], v[252:255], v[96:99]
    s_waitcnt lgkmcnt(4)
    v_mfma_f32_16x16x32_bf16 v[36:39], v[108:111], v[20:23], v[36:39]
    ds_read_b128 v[104:107], v18 offset:6144
    v_mfma_f32_16x16x32_bf16 v[40:43], v[108:111], v[22:25], v[40:43]
    v_mfma_f32_16x16x32_bf16 v[44:47], v[112:115], v[20:23], v[44:47]
    ds_read_b128 v[108:111], v18 offset:7168
    v_mfma_f32_16x16x32_bf16 v[48:51], v[112:115], v[22:25], v[48:51]
    s_waitcnt lgkmcnt(4)
    v_mfma_f32_16x16x32_bf16 v[52:55], v[116:119], v[20:23], v[52:55]
    ds_read_b128 v[112:115], v18 offset:8192
    v_mfma_f32_16x16x32_bf16 v[56:59], v[116:119], v[22:25], v[56:59]
    v_mfma_f32_16x16x32_bf16 v[60:63], v[120:123], v[20:23], v[60:63]
    ds_read_b128 v[116:119], v18 offset:9216
    v_mfma_f32_16x16x32_bf16 v[64:67], v[120:123], v[22:25], v[64:67]
    s_barrier
    s_waitcnt lgkmcnt(4)
    v_mfma_f32_16x16x32_bf16 v[68:71], v[124:127], v[20:23], v[68:71]
    ds_read_b128 v[120:123], v18 offset:10240
    v_mfma_f32_16x16x32_bf16 v[72:75], v[124:127], v[22:25], v[72:75]
    v_mfma_f32_16x16x32_bf16 v[76:79], v[100:103], v[20:23], v[76:79]
    ds_read_b128 v[124:127], v18 offset:11264
    v_mfma_f32_16x16x32_bf16 v[80:83], v[100:103], v[22:25], v[80:83]
    s_waitcnt lgkmcnt(4)
    v_mfma_f32_16x16x32_bf16 v[84:87], v[104:107], v[20:23], v[84:87]
    ds_read_b128 v[100:103], v18 offset:12288
    v_mfma_f32_16x16x32_bf16 v[88:91], v[104:107], v[22:25], v[88:91]
    v_mfma_f32_16x16x32_bf16 v[92:95], v[108:111], v[20:23], v[92:95]
    ds_read_b128 v[104:107], v18 offset:13312
    v_mfma_f32_16x16x32_bf16 v[96:99], v[108:111], v[22:25], v[96:99]
    v_pk_mul_f32 v[36:37], v[36:37], v[44:45]
    v_pk_mul_f32 v[38:39], v[38:39], v[46:47]
    v_pk_mul_f32 v[40:41], v[40:41], v[48:49]
    v_pk_mul_f32 v[42:43], v[42:43], v[50:51]
    v_pk_mul_f32 v[36:37], v[36:37], v[26:27] op_sel:[0,0] op_sel_hi:[1,0]
    v_pk_mul_f32 v[38:39], v[38:39], v[26:27] op_sel:[0,0] op_sel_hi:[1,0]
    v_pk_mul_f32 v[40:41], v[40:41], v[26:27] op_sel:[0,1] op_sel_hi:[1,1]
    v_pk_mul_f32 v[42:43], v[42:43], v[26:27] op_sel:[0,1] op_sel_hi:[1,1]
    v_cvt_pk_bf16_f32 v44, v36, v37
    v_cvt_pk_bf16_f32 v46, v40, v41
    v_cvt_pk_bf16_f32 v45, v38, v39
    v_cvt_pk_bf16_f32 v47, v42, v43
    v_permlane32_swap_b32 v44, v46
    s_nop 0
    v_permlane32_swap_b32 v45, v47
    buffer_store_dwordx4 v[44:47], v28, s[4:7], s34 offen offset:0 sc1
    v_pk_mul_f32 v[52:53], v[52:53], v[60:61]
    v_pk_mul_f32 v[54:55], v[54:55], v[62:63]
    v_pk_mul_f32 v[56:57], v[56:57], v[64:65]
    v_pk_mul_f32 v[58:59], v[58:59], v[66:67]
    v_pk_mul_f32 v[52:53], v[52:53], v[26:27] op_sel:[0,0] op_sel_hi:[1,0]
    v_pk_mul_f32 v[54:55], v[54:55], v[26:27] op_sel:[0,0] op_sel_hi:[1,0]
    v_pk_mul_f32 v[56:57], v[56:57], v[26:27] op_sel:[0,1] op_sel_hi:[1,1]
    v_pk_mul_f32 v[58:59], v[58:59], v[26:27] op_sel:[0,1] op_sel_hi:[1,1]
    v_cvt_pk_bf16_f32 v60, v52, v53
    v_cvt_pk_bf16_f32 v62, v56, v57
    v_cvt_pk_bf16_f32 v61, v54, v55
    v_cvt_pk_bf16_f32 v63, v58, v59
    v_permlane32_swap_b32 v60, v62
    s_nop 0
    v_permlane32_swap_b32 v61, v63
    buffer_store_dwordx4 v[60:63], v28, s[4:7], s34 offen offset:1024 sc1
    v_pk_mul_f32 v[68:69], v[68:69], v[76:77]
    v_pk_mul_f32 v[70:71], v[70:71], v[78:79]
    v_pk_mul_f32 v[72:73], v[72:73], v[80:81]
    v_pk_mul_f32 v[74:75], v[74:75], v[82:83]
    v_pk_mul_f32 v[68:69], v[68:69], v[26:27] op_sel:[0,0] op_sel_hi:[1,0]
    v_pk_mul_f32 v[70:71], v[70:71], v[26:27] op_sel:[0,0] op_sel_hi:[1,0]
    v_pk_mul_f32 v[72:73], v[72:73], v[26:27] op_sel:[0,1] op_sel_hi:[1,1]
    v_pk_mul_f32 v[74:75], v[74:75], v[26:27] op_sel:[0,1] op_sel_hi:[1,1]
    v_cvt_pk_bf16_f32 v76, v68, v69
    v_cvt_pk_bf16_f32 v78, v72, v73
    v_cvt_pk_bf16_f32 v77, v70, v71
    v_cvt_pk_bf16_f32 v79, v74, v75
    v_permlane32_swap_b32 v76, v78
    s_nop 0
    v_permlane32_swap_b32 v77, v79
    buffer_store_dwordx4 v[76:79], v28, s[4:7], s34 offen offset:2048 sc1
    v_pk_mul_f32 v[84:85], v[84:85], v[92:93]
    v_pk_mul_f32 v[86:87], v[86:87], v[94:95]
    v_pk_mul_f32 v[88:89], v[88:89], v[96:97]
    v_pk_mul_f32 v[90:91], v[90:91], v[98:99]
    v_pk_mul_f32 v[84:85], v[84:85], v[26:27] op_sel:[0,0] op_sel_hi:[1,0]
    v_pk_mul_f32 v[86:87], v[86:87], v[26:27] op_sel:[0,0] op_sel_hi:[1,0]
    v_pk_mul_f32 v[88:89], v[88:89], v[26:27] op_sel:[0,1] op_sel_hi:[1,1]
    v_pk_mul_f32 v[90:91], v[90:91], v[26:27] op_sel:[0,1] op_sel_hi:[1,1]
    v_cvt_pk_bf16_f32 v92, v84, v85
    v_cvt_pk_bf16_f32 v94, v88, v89
    v_cvt_pk_bf16_f32 v93, v86, v87
    v_cvt_pk_bf16_f32 v95, v90, v91
    v_permlane32_swap_b32 v92, v94
    s_nop 0
    v_permlane32_swap_b32 v93, v95
    buffer_store_dwordx4 v[92:95], v28, s[4:7], s34 offen offset:3072 sc1
    s_waitcnt lgkmcnt(4)
    v_mfma_f32_16x16x32_bf16 v[36:39], v[112:115], v[128:131], 0
    s_nop 0
    ds_read_b128 v[108:111], v18 offset:14336
    v_mfma_f32_16x16x32_bf16 v[40:43], v[112:115], v[132:135], 0
    s_nop 0
    v_mfma_f32_16x16x32_bf16 v[44:47], v[116:119], v[128:131], 0
    v_lshlrev_b32 v84, 16, v4
    ds_read_b128 v[112:115], v18 offset:15360
    v_mfma_f32_16x16x32_bf16 v[48:51], v[116:119], v[132:135], 0
    v_and_b32 v85, 0xffff0000, v4
    s_waitcnt lgkmcnt(4)
    v_mfma_f32_16x16x32_bf16 v[52:55], v[120:123], v[128:131], 0
    v_lshlrev_b32 v86, 16, v5
    ds_read_b128 v[116:119], v18 offset:16384
    v_mfma_f32_16x16x32_bf16 v[56:59], v[120:123], v[132:135], 0
    v_and_b32 v87, 0xffff0000, v5
    v_mfma_f32_16x16x32_bf16 v[60:63], v[124:127], v[128:131], 0
    v_lshlrev_b32 v92, 16, v6
    ds_read_b128 v[120:123], v18 offset:17408
    v_mfma_f32_16x16x32_bf16 v[64:67], v[124:127], v[132:135], 0
    v_and_b32 v93, 0xffff0000, v6
    s_waitcnt lgkmcnt(4)
    v_mfma_f32_16x16x32_bf16 v[36:39], v[100:103], v[136:139], v[36:39]
    v_lshlrev_b32 v94, 16, v7
    ds_read_b128 v[124:127], v18 offset:18432
    v_mfma_f32_16x16x32_bf16 v[40:43], v[100:103], v[140:143], v[40:43]
    v_and_b32 v95, 0xffff0000, v7
    v_mfma_f32_16x16x32_bf16 v[44:47], v[104:107], v[136:139], v[44:47]
    v_lshlrev_b32 v88, 16, v8
    ds_read_b128 v[100:103], v18 offset:19456
    v_mfma_f32_16x16x32_bf16 v[48:51], v[104:107], v[140:143], v[48:51]
    v_and_b32 v89, 0xffff0000, v8
    s_waitcnt lgkmcnt(4)
    v_mfma_f32_16x16x32_bf16 v[52:55], v[108:111], v[136:139], v[52:55]
    v_lshlrev_b32 v90, 16, v9
    ds_read_b128 v[104:107], v18 offset:20480
    v_mfma_f32_16x16x32_bf16 v[56:59], v[108:111], v[140:143], v[56:59]
    v_and_b32 v91, 0xffff0000, v9
    v_mfma_f32_16x16x32_bf16 v[60:63], v[112:115], v[136:139], v[60:63]
    v_lshlrev_b32 v96, 16, v10
    ds_read_b128 v[108:111], v18 offset:21504
    v_mfma_f32_16x16x32_bf16 v[64:67], v[112:115], v[140:143], v[64:67]
    v_and_b32 v97, 0xffff0000, v10
    s_waitcnt lgkmcnt(4)
    v_mfma_f32_16x16x32_bf16 v[36:39], v[116:119], v[144:147], v[36:39]
    v_lshlrev_b32 v98, 16, v11
    ds_read_b128 v[112:115], v18 offset:22528
    v_mfma_f32_16x16x32_bf16 v[40:43], v[116:119], v[148:151], v[40:43]
    v_and_b32 v99, 0xffff0000, v11
    v_mfma_f32_16x16x32_bf16 v[44:47], v[120:123], v[144:147], v[44:47]
    ds_read_b128 v[116:119], v18 offset:23552
    v_mfma_f32_16x16x32_bf16 v[48:51], v[120:123], v[148:151], v[48:51]
    s_barrier
    s_waitcnt lgkmcnt(4)
    v_mfma_f32_16x16x32_bf16 v[52:55], v[124:127], v[144:147], v[52:55]
    ds_read_b128 v[120:123], v18 offset:24576
    v_mfma_f32_16x16x32_bf16 v[56:59], v[124:127], v[148:151], v[56:59]
    v_mfma_f32_16x16x32_bf16 v[60:63], v[100:103], v[144:147], v[60:63]
    ds_read_b128 v[124:127], v18 offset:25600
    v_mfma_f32_16x16x32_bf16 v[64:67], v[100:103], v[148:151], v[64:67]
    s_waitcnt lgkmcnt(4)
    v_mfma_f32_16x16x32_bf16 v[36:39], v[104:107], v[152:155], v[36:39]
    ds_read_b128 v[100:103], v18 offset:26624
    v_mfma_f32_16x16x32_bf16 v[40:43], v[104:107], v[156:159], v[40:43]
    v_mfma_f32_16x16x32_bf16 v[44:47], v[108:111], v[152:155], v[44:47]
    ds_read_b128 v[104:107], v18 offset:27648
    v_mfma_f32_16x16x32_bf16 v[48:51], v[108:111], v[156:159], v[48:51]
    s_waitcnt lgkmcnt(4)
    v_mfma_f32_16x16x32_bf16 v[52:55], v[112:115], v[152:155], v[52:55]
    ds_read_b128 v[108:111], v18 offset:28672
    v_mfma_f32_16x16x32_bf16 v[56:59], v[112:115], v[156:159], v[56:59]
    v_mfma_f32_16x16x32_bf16 v[60:63], v[116:119], v[152:155], v[60:63]
    ds_read_b128 v[112:115], v18 offset:29696
    v_mfma_f32_16x16x32_bf16 v[64:67], v[116:119], v[156:159], v[64:67]
    s_waitcnt lgkmcnt(4)
    v_mfma_f32_16x16x32_bf16 v[36:39], v[120:123], v[160:163], v[36:39]
    ds_read_b128 v[116:119], v18 offset:30720
    v_mfma_f32_16x16x32_bf16 v[40:43], v[120:123], v[164:167], v[40:43]
    v_mfma_f32_16x16x32_bf16 v[44:47], v[124:127], v[160:163], v[44:47]
    ds_read_b128 v[120:123], v18 offset:31744
    v_mfma_f32_16x16x32_bf16 v[48:51], v[124:127], v[164:167], v[48:51]
    s_waitcnt lgkmcnt(4)
    v_mfma_f32_16x16x32_bf16 v[52:55], v[100:103], v[160:163], v[52:55]
    ds_read_b128 v[124:127], v16 offset:0
    v_mfma_f32_16x16x32_bf16 v[56:59], v[100:103], v[164:167], v[56:59]
    v_mfma_f32_16x16x32_bf16 v[60:63], v[104:107], v[160:163], v[60:63]
    ds_read_b128 v[100:103], v16 offset:1024
    v_mfma_f32_16x16x32_bf16 v[64:67], v[104:107], v[164:167], v[64:67]
    s_waitcnt lgkmcnt(4)
    v_mfma_f32_16x16x32_bf16 v[36:39], v[108:111], v[168:171], v[36:39]
    ds_read_b128 v[104:107], v16 offset:2048
    v_mfma_f32_16x16x32_bf16 v[40:43], v[108:111], v[172:175], v[40:43]
    v_mfma_f32_16x16x32_bf16 v[44:47], v[112:115], v[168:171], v[44:47]
    ds_read_b128 v[108:111], v16 offset:3072
    v_mfma_f32_16x16x32_bf16 v[48:51], v[112:115], v[172:175], v[48:51]
    s_waitcnt lgkmcnt(4)
    v_mfma_f32_16x16x32_bf16 v[52:55], v[116:119], v[168:171], v[52:55]
    ds_read_b128 v[112:115], v16 offset:4096
    v_mfma_f32_16x16x32_bf16 v[56:59], v[116:119], v[172:175], v[56:59]
    v_mfma_f32_16x16x32_bf16 v[60:63], v[120:123], v[168:171], v[60:63]
    ds_read_b128 v[116:119], v16 offset:5120
    v_mfma_f32_16x16x32_bf16 v[64:67], v[120:123], v[172:175], v[64:67]
    s_waitcnt lgkmcnt(4)
    v_mfma_f32_16x16x32_bf16 v[36:39], v[124:127], v[176:179], v[36:39]
    ds_read_b128 v[120:123], v16 offset:6144
    v_mfma_f32_16x16x32_bf16 v[40:43], v[124:127], v[180:183], v[40:43]
    v_mfma_f32_16x16x32_bf16 v[44:47], v[100:103], v[176:179], v[44:47]
    ds_read_b128 v[124:127], v16 offset:7168
    v_mfma_f32_16x16x32_bf16 v[48:51], v[100:103], v[180:183], v[48:51]
    s_barrier
    s_waitcnt lgkmcnt(4)
    v_mfma_f32_16x16x32_bf16 v[52:55], v[104:107], v[176:179], v[52:55]
    ds_read_b128 v[100:103], v16 offset:8192
    v_mfma_f32_16x16x32_bf16 v[56:59], v[104:107], v[180:183], v[56:59]
    v_mfma_f32_16x16x32_bf16 v[60:63], v[108:111], v[176:179], v[60:63]
    ds_read_b128 v[104:107], v16 offset:9216
    v_mfma_f32_16x16x32_bf16 v[64:67], v[108:111], v[180:183], v[64:67]
    s_waitcnt lgkmcnt(4)
    v_mfma_f32_16x16x32_bf16 v[36:39], v[112:115], v[184:187], v[36:39]
    ds_read_b128 v[108:111], v16 offset:10240
    v_mfma_f32_16x16x32_bf16 v[40:43], v[112:115], v[188:191], v[40:43]
    v_mfma_f32_16x16x32_bf16 v[44:47], v[116:119], v[184:187], v[44:47]
    ds_read_b128 v[112:115], v16 offset:11264
    v_mfma_f32_16x16x32_bf16 v[48:51], v[116:119], v[188:191], v[48:51]
    s_waitcnt lgkmcnt(4)
    v_mfma_f32_16x16x32_bf16 v[52:55], v[120:123], v[184:187], v[52:55]
    ds_read_b128 v[116:119], v16 offset:12288
    v_mfma_f32_16x16x32_bf16 v[56:59], v[120:123], v[188:191], v[56:59]
    v_mfma_f32_16x16x32_bf16 v[60:63], v[124:127], v[184:187], v[60:63]
    ds_read_b128 v[120:123], v16 offset:13312
    v_mfma_f32_16x16x32_bf16 v[64:67], v[124:127], v[188:191], v[64:67]
    s_waitcnt lgkmcnt(4)
    v_mfma_f32_16x16x32_bf16 v[36:39], v[100:103], v[192:195], v[36:39]
    ds_read_b128 v[124:127], v16 offset:14336
    v_mfma_f32_16x16x32_bf16 v[40:43], v[100:103], v[196:199], v[40:43]
    v_mfma_f32_16x16x32_bf16 v[44:47], v[104:107], v[192:195], v[44:47]
    ds_read_b128 v[100:103], v16 offset:15360
    v_mfma_f32_16x16x32_bf16 v[48:51], v[104:107], v[196:199], v[48:51]
    s_waitcnt vmcnt(0)
    s_add_u32 s54, s50, 0
    s_mov_b32 s38, 1
    s_atomic_add s38, s[14:15], s54
    s_waitcnt lgkmcnt(4)
    v_mfma_f32_16x16x32_bf16 v[52:55], v[108:111], v[192:195], v[52:55]
    ds_read_b128 v[104:107], v16 offset:16384
    v_mfma_f32_16x16x32_bf16 v[56:59], v[108:111], v[196:199], v[56:59]
    v_mfma_f32_16x16x32_bf16 v[60:63], v[112:115], v[192:195], v[60:63]
    ds_read_b128 v[108:111], v16 offset:17408
    v_mfma_f32_16x16x32_bf16 v[64:67], v[112:115], v[196:199], v[64:67]
    s_waitcnt lgkmcnt(4)
    v_mfma_f32_16x16x32_bf16 v[36:39], v[116:119], v[200:203], v[36:39]
    ds_read_b128 v[112:115], v16 offset:18432
    v_mfma_f32_16x16x32_bf16 v[40:43], v[116:119], v[204:207], v[40:43]
    v_mfma_f32_16x16x32_bf16 v[44:47], v[120:123], v[200:203], v[44:47]
    ds_read_b128 v[116:119], v16 offset:19456
    v_mfma_f32_16x16x32_bf16 v[48:51], v[120:123], v[204:207], v[48:51]
    s_waitcnt lgkmcnt(4)
    v_mfma_f32_16x16x32_bf16 v[52:55], v[124:127], v[200:203], v[52:55]
    ds_read_b128 v[120:123], v16 offset:20480
    v_mfma_f32_16x16x32_bf16 v[56:59], v[124:127], v[204:207], v[56:59]
    v_mfma_f32_16x16x32_bf16 v[60:63], v[100:103], v[200:203], v[60:63]
    ds_read_b128 v[124:127], v16 offset:21504
    v_mfma_f32_16x16x32_bf16 v[64:67], v[100:103], v[204:207], v[64:67]
    s_waitcnt lgkmcnt(4)
    v_mfma_f32_16x16x32_bf16 v[36:39], v[104:107], v[208:211], v[36:39]
    ds_read_b128 v[100:103], v16 offset:22528
    v_mfma_f32_16x16x32_bf16 v[40:43], v[104:107], v[212:215], v[40:43]
    v_mfma_f32_16x16x32_bf16 v[44:47], v[108:111], v[208:211], v[44:47]
    ds_read_b128 v[104:107], v16 offset:23552
    v_mfma_f32_16x16x32_bf16 v[48:51], v[108:111], v[212:215], v[48:51]
    s_barrier
    s_waitcnt lgkmcnt(4)
    v_mfma_f32_16x16x32_bf16 v[52:55], v[112:115], v[208:211], v[52:55]
    ds_read_b128 v[108:111], v16 offset:24576
    v_mfma_f32_16x16x32_bf16 v[56:59], v[112:115], v[212:215], v[56:59]
    v_mfma_f32_16x16x32_bf16 v[60:63], v[116:119], v[208:211], v[60:63]
    ds_read_b128 v[112:115], v16 offset:25600
    v_mfma_f32_16x16x32_bf16 v[64:67], v[116:119], v[212:215], v[64:67]
    s_waitcnt lgkmcnt(4)
    v_mfma_f32_16x16x32_bf16 v[36:39], v[120:123], v[216:219], v[36:39]
    ds_read_b128 v[116:119], v16 offset:26624
    v_mfma_f32_16x16x32_bf16 v[40:43], v[120:123], v[220:223], v[40:43]
    v_mfma_f32_16x16x32_bf16 v[44:47], v[124:127], v[216:219], v[44:47]
    ds_read_b128 v[120:123], v16 offset:27648
    v_mfma_f32_16x16x32_bf16 v[48:51], v[124:127], v[220:223], v[48:51]
    s_waitcnt lgkmcnt(4)
    v_mfma_f32_16x16x32_bf16 v[52:55], v[100:103], v[216:219], v[52:55]
    ds_read_b128 v[124:127], v16 offset:28672
    v_mfma_f32_16x16x32_bf16 v[56:59], v[100:103], v[220:223], v[56:59]
    v_mfma_f32_16x16x32_bf16 v[60:63], v[104:107], v[216:219], v[60:63]
    ds_read_b128 v[100:103], v16 offset:29696
    v_mfma_f32_16x16x32_bf16 v[64:67], v[104:107], v[220:223], v[64:67]
    s_waitcnt lgkmcnt(4)
    v_mfma_f32_16x16x32_bf16 v[36:39], v[108:111], v[224:227], v[36:39]
    ds_read_b128 v[104:107], v16 offset:30720
    v_mfma_f32_16x16x32_bf16 v[40:43], v[108:111], v[228:231], v[40:43]
    v_mfma_f32_16x16x32_bf16 v[44:47], v[112:115], v[224:227], v[44:47]
    ds_read_b128 v[108:111], v16 offset:31744
    v_mfma_f32_16x16x32_bf16 v[48:51], v[112:115], v[228:231], v[48:51]
    s_waitcnt lgkmcnt(4)
    v_mfma_f32_16x16x32_bf16 v[52:55], v[116:119], v[224:227], v[52:55]
    ds_read_b128 v[112:115], v16 offset:32768
    v_mfma_f32_16x16x32_bf16 v[56:59], v[116:119], v[228:231], v[56:59]
    v_mfma_f32_16x16x32_bf16 v[60:63], v[120:123], v[224:227], v[60:63]
    ds_read_b128 v[116:119], v16 offset:33792
    v_mfma_f32_16x16x32_bf16 v[64:67], v[120:123], v[228:231], v[64:67]
    s_waitcnt lgkmcnt(4)
    v_mfma_f32_16x16x32_bf16 v[36:39], v[124:127], v[232:235], v[36:39]
    ds_read_b128 v[120:123], v16 offset:34816
    v_mfma_f32_16x16x32_bf16 v[40:43], v[124:127], v[236:239], v[40:43]
    v_mfma_f32_16x16x32_bf16 v[44:47], v[100:103], v[232:235], v[44:47]
    ds_read_b128 v[124:127], v16 offset:35840
    v_mfma_f32_16x16x32_bf16 v[48:51], v[100:103], v[236:239], v[48:51]
    s_waitcnt lgkmcnt(4)
    v_mfma_f32_16x16x32_bf16 v[52:55], v[104:107], v[232:235], v[52:55]
    ds_read_b128 v[100:103], v16 offset:36864
    v_mfma_f32_16x16x32_bf16 v[56:59], v[104:107], v[236:239], v[56:59]
    v_mfma_f32_16x16x32_bf16 v[60:63], v[108:111], v[232:235], v[60:63]
    ds_read_b128 v[104:107], v16 offset:37888
    v_mfma_f32_16x16x32_bf16 v[64:67], v[108:111], v[236:239], v[64:67]
    s_waitcnt lgkmcnt(4)
    v_mfma_f32_16x16x32_bf16 v[36:39], v[112:115], v[240:243], v[36:39]
    ds_read_b128 v[108:111], v16 offset:38912
    v_mfma_f32_16x16x32_bf16 v[40:43], v[112:115], v[244:247], v[40:43]
    v_mfma_f32_16x16x32_bf16 v[44:47], v[116:119], v[240:243], v[44:47]
    ds_read_b128 v[112:115], v16 offset:39936
    v_mfma_f32_16x16x32_bf16 v[48:51], v[116:119], v[244:247], v[48:51]
    s_barrier
    s_waitcnt lgkmcnt(4)
    v_mfma_f32_16x16x32_bf16 v[52:55], v[120:123], v[240:243], v[52:55]
    ds_read_b128 v[116:119], v16 offset:40960
    v_mfma_f32_16x16x32_bf16 v[56:59], v[120:123], v[244:247], v[56:59]
    v_mfma_f32_16x16x32_bf16 v[60:63], v[124:127], v[240:243], v[60:63]
    ds_read_b128 v[120:123], v16 offset:41984
    v_mfma_f32_16x16x32_bf16 v[64:67], v[124:127], v[244:247], v[64:67]
    s_add_u32 s28, s52, 0
    s_mov_b32 s55, 0
    s_atomic_add s55, s[14:15], s28 glc
    s_waitcnt lgkmcnt(4)
    v_mfma_f32_16x16x32_bf16 v[36:39], v[100:103], v[248:251], v[36:39]
    ds_read_b128 v[124:127], v16 offset:43008
    v_mfma_f32_16x16x32_bf16 v[40:43], v[100:103], v[252:255], v[40:43]
    v_mfma_f32_16x16x32_bf16 v[44:47], v[104:107], v[248:251], v[44:47]
    ds_read_b128 v[100:103], v16 offset:44032
    v_mfma_f32_16x16x32_bf16 v[48:51], v[104:107], v[252:255], v[48:51]
    s_waitcnt lgkmcnt(4)
    v_mfma_f32_16x16x32_bf16 v[52:55], v[108:111], v[248:251], v[52:55]
    ds_read_b128 v[104:107], v16 offset:45056
    v_mfma_f32_16x16x32_bf16 v[56:59], v[108:111], v[252:255], v[56:59]
    v_mfma_f32_16x16x32_bf16 v[60:63], v[112:115], v[248:251], v[60:63]
    ds_read_b128 v[108:111], v16 offset:46080
    v_mfma_f32_16x16x32_bf16 v[64:67], v[112:115], v[252:255], v[64:67]
    s_waitcnt lgkmcnt(4)
    v_mfma_f32_16x16x32_bf16 v[36:39], v[116:119], v[20:23], v[36:39]
    ds_read_b128 v[112:115], v16 offset:47104
    v_mfma_f32_16x16x32_bf16 v[40:43], v[116:119], v[22:25], v[40:43]
    v_mfma_f32_16x16x32_bf16 v[44:47], v[120:123], v[20:23], v[44:47]
    ds_read_b128 v[116:119], v16 offset:48128
    v_mfma_f32_16x16x32_bf16 v[48:51], v[120:123], v[22:25], v[48:51]
    s_waitcnt lgkmcnt(4)
    v_mfma_f32_16x16x32_bf16 v[52:55], v[124:127], v[20:23], v[52:55]
    ds_read_b128 v[120:123], v16 offset:49152
    v_mfma_f32_16x16x32_bf16 v[56:59], v[124:127], v[22:25], v[56:59]
    v_mfma_f32_16x16x32_bf16 v[60:63], v[100:103], v[20:23], v[60:63]
    ds_read_b128 v[124:127], v16 offset:50176
    v_mfma_f32_16x16x32_bf16 v[64:67], v[100:103], v[22:25], v[64:67]
    v_pk_mul_f32 v[36:37], v[36:37], v[44:45]
    v_pk_mul_f32 v[38:39], v[38:39], v[46:47]
    v_pk_mul_f32 v[40:41], v[40:41], v[48:49]
    v_pk_mul_f32 v[42:43], v[42:43], v[50:51]
    v_pk_mul_f32 v[36:37], v[36:37], v[26:27] op_sel:[0,0] op_sel_hi:[1,0]
    v_pk_mul_f32 v[38:39], v[38:39], v[26:27] op_sel:[0,0] op_sel_hi:[1,0]
    v_pk_mul_f32 v[40:41], v[40:41], v[26:27] op_sel:[0,1] op_sel_hi:[1,1]
    v_pk_mul_f32 v[42:43], v[42:43], v[26:27] op_sel:[0,1] op_sel_hi:[1,1]
    v_cvt_pk_bf16_f32 v44, v36, v37
    v_cvt_pk_bf16_f32 v46, v40, v41
    v_cvt_pk_bf16_f32 v45, v38, v39
    v_cvt_pk_bf16_f32 v47, v42, v43
    v_permlane32_swap_b32 v44, v46
    s_nop 0
    v_permlane32_swap_b32 v45, v47
    buffer_store_dwordx4 v[44:47], v28, s[4:7], s35 offen offset:0 sc1
    v_pk_mul_f32 v[52:53], v[52:53], v[60:61]
    v_pk_mul_f32 v[54:55], v[54:55], v[62:63]
    v_pk_mul_f32 v[56:57], v[56:57], v[64:65]
    v_pk_mul_f32 v[58:59], v[58:59], v[66:67]
    v_pk_mul_f32 v[52:53], v[52:53], v[26:27] op_sel:[0,0] op_sel_hi:[1,0]
    v_pk_mul_f32 v[54:55], v[54:55], v[26:27] op_sel:[0,0] op_sel_hi:[1,0]
    v_pk_mul_f32 v[56:57], v[56:57], v[26:27] op_sel:[0,1] op_sel_hi:[1,1]
    v_pk_mul_f32 v[58:59], v[58:59], v[26:27] op_sel:[0,1] op_sel_hi:[1,1]
    v_cvt_pk_bf16_f32 v60, v52, v53
    v_cvt_pk_bf16_f32 v62, v56, v57
    v_cvt_pk_bf16_f32 v61, v54, v55
    v_cvt_pk_bf16_f32 v63, v58, v59
    v_permlane32_swap_b32 v60, v62
    s_nop 0
    v_permlane32_swap_b32 v61, v63
    buffer_store_dwordx4 v[60:63], v28, s[4:7], s35 offen offset:1024 sc1
    s_waitcnt lgkmcnt(4)
    v_mfma_f32_16x16x32_bf16 v[68:71], v[104:107], v[128:131], 0
    ds_read_b128 v[100:103], v16 offset:51200
    v_mfma_f32_16x16x32_bf16 v[72:75], v[104:107], v[132:135], 0
    v_mfma_f32_16x16x32_bf16 v[76:79], v[108:111], v[128:131], 0
    ds_read_b128 v[104:107], v16 offset:52224
    v_mfma_f32_16x16x32_bf16 v[80:83], v[108:111], v[132:135], 0
    s_waitcnt lgkmcnt(4)
    v_mfma_f32_16x16x32_bf16 v[68:71], v[112:115], v[136:139], v[68:71]
    ds_read_b128 v[108:111], v16 offset:53248
    v_mfma_f32_16x16x32_bf16 v[72:75], v[112:115], v[140:143], v[72:75]
    v_mfma_f32_16x16x32_bf16 v[76:79], v[116:119], v[136:139], v[76:79]
    ds_read_b128 v[112:115], v16 offset:54272
    v_mfma_f32_16x16x32_bf16 v[80:83], v[116:119], v[140:143], v[80:83]
    s_waitcnt lgkmcnt(4)
    v_mfma_f32_16x16x32_bf16 v[68:71], v[120:123], v[144:147], v[68:71]
    ds_read_b128 v[116:119], v16 offset:55296
    v_mfma_f32_16x16x32_bf16 v[72:75], v[120:123], v[148:151], v[72:75]
    v_mfma_f32_16x16x32_bf16 v[76:79], v[124:127], v[144:147], v[76:79]
    ds_read_b128 v[120:123], v16 offset:56320
    v_mfma_f32_16x16x32_bf16 v[80:83], v[124:127], v[148:151], v[80:83]
    s_barrier
    s_waitcnt lgkmcnt(4)
    v_mfma_f32_16x16x32_bf16 v[68:71], v[100:103], v[152:155], v[68:71]
    ds_read_b128 v[124:127], v16 offset:57344
    v_mfma_f32_16x16x32_bf16 v[72:75], v[100:103], v[156:159], v[72:75]
    v_mfma_f32_16x16x32_bf16 v[76:79], v[104:107], v[152:155], v[76:79]
    ds_read_b128 v[100:103], v16 offset:58368
    v_mfma_f32_16x16x32_bf16 v[80:83], v[104:107], v[156:159], v[80:83]
    s_waitcnt lgkmcnt(4)
    v_mfma_f32_16x16x32_bf16 v[68:71], v[108:111], v[160:163], v[68:71]
    ds_read_b128 v[104:107], v16 offset:59392
    v_mfma_f32_16x16x32_bf16 v[72:75], v[108:111], v[164:167], v[72:75]
    v_mfma_f32_16x16x32_bf16 v[76:79], v[112:115], v[160:163], v[76:79]
    ds_read_b128 v[108:111], v16 offset:60416
    v_mfma_f32_16x16x32_bf16 v[80:83], v[112:115], v[164:167], v[80:83]
    s_waitcnt lgkmcnt(4)
    v_mfma_f32_16x16x32_bf16 v[68:71], v[116:119], v[168:171], v[68:71]
    ds_read_b128 v[112:115], v16 offset:61440
    v_mfma_f32_16x16x32_bf16 v[72:75], v[116:119], v[172:175], v[72:75]
    v_mfma_f32_16x16x32_bf16 v[76:79], v[120:123], v[168:171], v[76:79]
    ds_read_b128 v[116:119], v16 offset:62464
    v_mfma_f32_16x16x32_bf16 v[80:83], v[120:123], v[172:175], v[80:83]
    s_waitcnt lgkmcnt(4)
    v_mfma_f32_16x16x32_bf16 v[68:71], v[124:127], v[176:179], v[68:71]
    ds_read_b128 v[120:123], v16 offset:63488
    v_mfma_f32_16x16x32_bf16 v[72:75], v[124:127], v[180:183], v[72:75]
    v_mfma_f32_16x16x32_bf16 v[76:79], v[100:103], v[176:179], v[76:79]
    ds_read_b128 v[124:127], v16 offset:64512
    v_mfma_f32_16x16x32_bf16 v[80:83], v[100:103], v[180:183], v[80:83]
    s_waitcnt lgkmcnt(0)
    s_cmp_ge_u32 s55, 16
    s_cbranch_scc1 L_go_58
    s_mov_b32 s39, 1048576
L_poll_59:
    s_mov_b32 s49, 0
    s_atomic_add s49, s[14:15], s28 glc
    s_sub_u32 s39, s39, 1
    s_waitcnt lgkmcnt(0)
    s_cmp_ge_u32 s49, 16
    s_cbranch_scc1 L_pok_60
    s_sleep 1
    s_cmp_lg_u32 s39, 0
    s_cbranch_scc1 L_poll_59
L_pok_60:
L_go_58:
    s_waitcnt lgkmcnt(4)
    v_mfma_f32_16x16x32_bf16 v[68:71], v[104:107], v[184:187], v[68:71]
    ds_read_b128 v[100:103], v17 offset:0
    v_mfma_f32_16x16x32_bf16 v[72:75], v[104:107], v[188:191], v[72:75]
    buffer_load_dwordx4 v[128:131], v15, s[4:7], s37 offen offset:0 sc1
    v_mfma_f32_16x16x32_bf16 v[76:79], v[108:111], v[184:187], v[76:79]
    ds_read_b128 v[104:107], v17 offset:1024
    v_mfma_f32_16x16x32_bf16 v[80:83], v[108:111], v[188:191], v[80:83]
    buffer_load_dwordx4 v[132:135], v15, s[4:7], s37 offen offset:256 sc1
    s_add_u32 s37, s37, 4096
    s_waitcnt lgkmcnt(4)
    v_mfma_f32_16x16x32_bf16 v[68:71], v[112:115], v[192:195], v[68:71]
    ds_read_b128 v[108:111], v17 offset:2048
    v_mfma_f32_16x16x32_bf16 v[72:75], v[112:115], v[196:199], v[72:75]
    buffer_load_dwordx4 v[136:139], v15, s[4:7], s37 offen offset:0 sc1
    v_mfma_f32_16x16x32_bf16 v[76:79], v[116:119], v[192:195], v[76:79]
    ds_read_b128 v[112:115], v17 offset:3072
    v_mfma_f32_16x16x32_bf16 v[80:83], v[116:119], v[196:199], v[80:83]
    buffer_load_dwordx4 v[140:143], v15, s[4:7], s37 offen offset:256 sc1
    s_add_u32 s37, s37, 4096
    s_waitcnt lgkmcnt(4)
    v_mfma_f32_16x16x32_bf16 v[68:71], v[120:123], v[200:203], v[68:71]
    ds_read_b128 v[116:119], v17 offset:4096
    v_mfma_f32_16x16x32_bf16 v[72:75], v[120:123], v[204:207], v[72:75]
    buffer_load_dwordx4 v[144:147], v15, s[4:7], s37 offen offset:0 sc1
    v_mfma_f32_16x16x32_bf16 v[76:79], v[124:127], v[200:203], v[76:79]
    ds_read_b128 v[120:123], v17 offset:5120
    v_mfma_f32_16x16x32_bf16 v[80:83], v[124:127], v[204:207], v[80:83]
    buffer_load_dwordx4 v[148:151], v15, s[4:7], s37 offen offset:256 sc1
    s_add_u32 s37, s37, 4096
    s_waitcnt lgkmcnt(4)
    v_mfma_f32_16x16x32_bf16 v[68:71], v[100:103], v[208:211], v[68:71]
    ds_read_b128 v[124:127], v17 offset:6144
    v_mfma_f32_16x16x32_bf16 v[72:75], v[100:103], v[212:215], v[72:75]
    buffer_load_dwordx4 v[152:155], v15, s[4:7], s37 offen offset:0 sc1
    v_mfma_f32_16x16x32_bf16 v[76:79], v[104:107], v[208:211], v[76:79]
    ds_read_b128 v[100:103], v17 offset:7168
    v_mfma_f32_16x16x32_bf16 v[80:83], v[104:107], v[212:215], v[80:83]
    buffer_load_dwordx4 v[156:159], v15, s[4:7], s37 offen offset:256 sc1
    s_add_u32 s37, s37, 4096
    s_barrier
    s_waitcnt lgkmcnt(4)
    v_mfma_f32_16x16x32_bf16 v[68:71], v[108:111], v[216:219], v[68:71]
    ds_read_b128 v[104:107], v17 offset:8192
    v_mfma_f32_16x16x32_bf16 v[72:75], v[108:111], v[220:223], v[72:75]
    buffer_load_dwordx4 v[160:163], v15, s[4:7], s37 offen offset:0 sc1
    v_mfma_f32_16x16x32_bf16 v[76:79], v[112:115], v[216:219], v[76:79]
    ds_read_b128 v[108:111], v17 offset:9216
    v_mfma_f32_16x16x32_bf16 v[80:83], v[112:115], v[220:223], v[80:83]
    buffer_load_dwordx4 v[164:167], v15, s[4:7], s37 offen offset:256 sc1
    s_add_u32 s37, s37, 4096
    s_waitcnt lgkmcnt(4)
    v_mfma_f32_16x16x32_bf16 v[68:71], v[116:119], v[224:227], v[68:71]
    ds_read_b128 v[112:115], v17 offset:10240
    v_mfma_f32_16x16x32_bf16 v[72:75], v[116:119], v[228:231], v[72:75]
    buffer_load_dwordx4 v[168:171], v15, s[4:7], s37 offen offset:0 sc1
    v_mfma_f32_16x16x32_bf16 v[76:79], v[120:123], v[224:227], v[76:79]
    ds_read_b128 v[116:119], v17 offset:11264
    v_mfma_f32_16x16x32_bf16 v[80:83], v[120:123], v[228:231], v[80:83]
    buffer_load_dwordx4 v[172:175], v15, s[4:7], s37 offen offset:256 sc1
    s_add_u32 s37, s37, 4096
    s_waitcnt lgkmcnt(4)
    v_mfma_f32_16x16x32_bf16 v[68:71], v[124:127], v[232:235], v[68:71]
    ds_read_b128 v[120:123], v17 offset:12288
    v_mfma_f32_16x16x32_bf16 v[72:75], v[124:127], v[236:239], v[72:75]
    buffer_load_dwordx4 v[176:179], v15, s[4:7], s37 offen offset:0 sc1
    v_mfma_f32_16x16x32_bf16 v[76:79], v[100:103], v[232:235], v[76:79]
    ds_read_b128 v[124:127], v17 offset:13312
    v_mfma_f32_16x16x32_bf16 v[80:83], v[100:103], v[236:239], v[80:83]
    buffer_load_dwordx4 v[180:183], v15, s[4:7], s37 offen offset:256 sc1
    s_add_u32 s37, s37, 4096
    s_waitcnt lgkmcnt(4)
    v_mfma_f32_16x16x32_bf16 v[68:71], v[104:107], v[240:243], v[68:71]
    ds_read_b128 v[100:103], v31 offset:16384
    v_mfma_f32_16x16x32_bf16 v[72:75], v[104:107], v[244:247], v[72:75]
    buffer_load_dwordx4 v[184:187], v15, s[4:7], s37 offen offset:0 sc1
    v_mfma_f32_16x16x32_bf16 v[76:79], v[108:111], v[240:243], v[76:79]
    ds_read_b128 v[104:107], v31 offset:17408
    v_mfma_f32_16x16x32_bf16 v[80:83], v[108:111], v[244:247], v[80:83]
    buffer_load_dwordx4 v[188:191], v15, s[4:7], s37 offen offset:256 sc1
    s_add_u32 s37, s37, 4096
    s_waitcnt lgkmcnt(4)
    v_mfma_f32_16x16x32_bf16 v[68:71], v[112:115], v[248:251], v[68:71]
    ds_read_b128 v[108:111], v34 offset:16384
    v_mfma_f32_16x16x32_bf16 v[72:75], v[112:115], v[252:255], v[72:75]
    v_mfma_f32_16x16x32_bf16 v[76:79], v[116:119], v[248:251], v[76:79]
    ds_read_b128 v[112:115], v34 offset:17408
    v_mfma_f32_16x16x32_bf16 v[80:83], v[116:119], v[252:255], v[80:83]
    s_waitcnt lgkmcnt(4)
    v_mfma_f32_16x16x32_bf16 v[68:71], v[120:123], v[20:23], v[68:71]
    ds_read_b128 v[116:119], v31 offset:24576
    v_mfma_f32_16x16x32_bf16 v[72:75], v[120:123], v[22:25], v[72:75]
    v_mfma_f32_16x16x32_bf16 v[76:79], v[124:127], v[20:23], v[76:79]
    ds_read_b128 v[120:123], v31 offset:25600
    v_mfma_f32_16x16x32_bf16 v[80:83], v[124:127], v[22:25], v[80:83]
    s_nop 7
    v_pk_mul_f32 v[68:69], v[68:69], v[76:77]
    v_pk_mul_f32 v[70:71], v[70:71], v[78:79]
    v_pk_mul_f32 v[72:73], v[72:73], v[80:81]
    v_pk_mul_f32 v[74:75], v[74:75], v[82:83]
    v_pk_mul_f32 v[68:69], v[68:69], v[26:27] op_sel:[0,0] op_sel_hi:[1,0]
    v_pk_mul_f32 v[70:71], v[70:71], v[26:27] op_sel:[0,0] op_sel_hi:[1,0]
    v_pk_mul_f32 v[72:73], v[72:73], v[26:27] op_sel:[0,1] op_sel_hi:[1,1]
    v_pk_mul_f32 v[74:75], v[74:75], v[26:27] op_sel:[0,1] op_sel_hi:[1,1]
    v_cvt_pk_bf16_f32 v76, v68, v69
    v_cvt_pk_bf16_f32 v78, v72, v73
    v_cvt_pk_bf16_f32 v77, v70, v71
    v_cvt_pk_bf16_f32 v79, v74, v75
    v_permlane32_swap_b32 v76, v78
    s_nop 0
    v_permlane32_swap_b32 v77, v79
    buffer_store_dwordx4 v[76:79], v28, s[4:7], s32 offen offset:0 sc1
    s_waitcnt lgkmcnt(4)
    s_waitcnt vmcnt(15)
    v_mfma_f32_16x16x32_bf16 v[84:87], v[100:103], v[128:131], v[84:87]
    ds_read_b128 v[124:127], v34 offset:24576
    v_mfma_f32_16x16x32_bf16 v[88:91], v[100:103], v[132:135], v[88:91]
    v_mfma_f32_16x16x32_bf16 v[92:95], v[104:107], v[128:131], v[92:95]
    ds_read_b128 v[100:103], v34 offset:25600
    v_mfma_f32_16x16x32_bf16 v[96:99], v[104:107], v[132:135], v[96:99]
    s_add_u32 s54, s50, 4
    s_mov_b32 s38, 1
    s_atomic_add s38, s[14:15], s54
    s_waitcnt lgkmcnt(4)
    v_mfma_f32_16x16x32_bf16 v[36:39], v[108:111], v[128:131], 0
    ds_read_b128 v[104:107], v31 offset:32768
    v_mfma_f32_16x16x32_bf16 v[40:43], v[108:111], v[132:135], 0
    v_mfma_f32_16x16x32_bf16 v[44:47], v[112:115], v[128:131], 0
    ds_read_b128 v[108:111], v31 offset:33792
    v_mfma_f32_16x16x32_bf16 v[48:51], v[112:115], v[132:135], 0
    s_waitcnt lgkmcnt(4)
    s_waitcnt vmcnt(13)
    v_mfma_f32_16x16x32_bf16 v[84:87], v[116:119], v[136:139], v[84:87]
    ds_read_b128 v[112:115], v34 offset:32768
    v_mfma_f32_16x16x32_bf16 v[88:91], v[116:119], v[140:143], v[88:91]
    v_mfma_f32_16x16x32_bf16 v[92:95], v[120:123], v[136:139], v[92:95]
    ds_read_b128 v[116:119], v34 offset:33792
    v_mfma_f32_16x16x32_bf16 v[96:99], v[120:123], v[140:143], v[96:99]
    s_waitcnt lgkmcnt(4)
    v_mfma_f32_16x16x32_bf16 v[36:39], v[124:127], v[136:139], v[36:39]
    ds_read_b128 v[120:123], v31 offset:40960
    v_mfma_f32_16x16x32_bf16 v[40:43], v[124:127], v[140:143], v[40:43]
    v_mfma_f32_16x16x32_bf16 v[44:47], v[100:103], v[136:139], v[44:47]
    ds_read_b128 v[124:127], v31 offset:41984
    v_mfma_f32_16x16x32_bf16 v[48:51], v[100:103], v[140:143], v[48:51]
    s_barrier
    s_waitcnt lgkmcnt(4)
    s_waitcnt vmcnt(11)
    v_mfma_f32_16x16x32_bf16 v[84:87], v[104:107], v[144:147], v[84:87]
    ds_read_b128 v[100:103], v34 offset:40960
    v_mfma_f32_16x16x32_bf16 v[88:91], v[104:107], v[148:151], v[88:91]
    v_mfma_f32_16x16x32_bf16 v[92:95], v[108:111], v[144:147], v[92:95]
    ds_read_b128 v[104:107], v34 offset:41984
    v_mfma_f32_16x16x32_bf16 v[96:99], v[108:111], v[148:151], v[96:99]
    buffer_load_dwordx4 v[192:195], v15, s[4:7], s37 offen offset:0 sc1
    s_waitcnt lgkmcnt(4)
    v_mfma_f32_16x16x32_bf16 v[36:39], v[112:115], v[144:147], v[36:39]
    ds_read_b128 v[108:111], v31 offset:49152
    v_mfma_f32_16x16x32_bf16 v[40:43], v[112:115], v[148:151], v[40:43]
    v_mfma_f32_16x16x32_bf16 v[44:47], v[116:119], v[144:147], v[44:47]
    ds_read_b128 v[112:115], v31 offset:50176
    v_mfma_f32_16x16x32_bf16 v[48:51], v[116:119], v[148:151], v[48:51]
    buffer_load_dwordx4 v[196:199], v15, s[4:7], s37 offen offset:256 sc1
    s_add_u32 s37, s37, 4096
    s_waitcnt lgkmcnt(4)
    s_waitcnt vmcnt(11)
    v_mfma_f32_16x16x32_bf16 v[84:87], v[120:123], v[152:155], v[84:87]
    ds_read_b128 v[116:119], v34 offset:49152
    v_mfma_f32_16x16x32_bf16 v[88:91], v[120:123], v[156:159], v[88:91]
    v_mfma_f32_16x16x32_bf16 v[92:95], v[124:127], v[152:155], v[92:95]
    ds_read_b128 v[120:123], v34 offset:50176
    v_mfma_f32_16x16x32_bf16 v[96:99], v[124:127], v[156:159], v[96:99]
    buffer_load_dwordx4 v[200:203], v15, s[4:7], s37 offen offset:0 sc1
    s_waitcnt lgkmcnt(4)
    v_mfma_f32_16x16x32_bf16 v[36:39], v[100:103], v[152:155], v[36:39]
    ds_read_b128 v[124:127], v31 offset:57344
    v_mfma_f32_16x16x32_bf16 v[40:43], v[100:103], v[156:159], v[40:43]
    v_mfma_f32_16x16x32_bf16 v[44:47], v[104:107], v[152:155], v[44:47]
    ds_read_b128 v[100:103], v31 offset:58368
    v_mfma_f32_16x16x32_bf16 v[48:51], v[104:107], v[156:159], v[48:51]
    buffer_load_dwordx4 v[204:207], v15, s[4:7], s37 offen offset:256 sc1
    s_add_u32 s37, s37, 4096
    s_waitcnt lgkmcnt(4)
    s_waitcnt vmcnt(11)
    v_mfma_f32_16x16x32_bf16 v[84:87], v[108:111], v[160:163], v[84:87]
    ds_read_b128 v[104:107], v34 offset:57344
    v_mfma_f32_16x16x32_bf16 v[88:91], v[108:111], v[164:167], v[88:91]
    v_mfma_f32_16x16x32_bf16 v[92:95], v[112:115], v[160:163], v[92:95]
    ds_read_b128 v[108:111], v34 offset:58368
    v_mfma_f32_16x16x32_bf16 v[96:99], v[112:115], v[164:167], v[96:99]
    buffer_load_dwordx4 v[208:211], v15, s[4:7], s37 offen offset:0 sc1
    s_waitcnt lgkmcnt(4)
    v_mfma_f32_16x16x32_bf16 v[36:39], v[116:119], v[160:163], v[36:39]
    ds_read_b128 v[112:115], v32 offset:0
    v_mfma_f32_16x16x32_bf16 v[40:43], v[116:119], v[164:167], v[40:43]
    v_mfma_f32_16x16x32_bf16 v[44:47], v[120:123], v[160:163], v[44:47]
    ds_read_b128 v[116:119], v32 offset:1024
    v_mfma_f32_16x16x32_bf16 v[48:51], v[120:123], v[164:167], v[48:51]
    buffer_load_dwordx4 v[212:215], v15, s[4:7], s37 offen offset:256 sc1
    s_add_u32 s37, s37, 4096
    s_barrier
    s_waitcnt lgkmcnt(4)
    s_waitcnt vmcnt(11)
    v_mfma_f32_16x16x32_bf16 v[84:87], v[124:127], v[168:171], v[84:87]
    ds_read_b128 v[120:123], v35 offset:0
    v_mfma_f32_16x16x32_bf16 v[88:91], v[124:127], v[172:175], v[88:91]
    v_mfma_f32_16x16x32_bf16 v[92:95], v[100:103], v[168:171], v[92:95]
    ds_read_b128 v[124:127], v35 offset:1024
    v_mfma_f32_16x16x32_bf16 v[96:99], v[100:103], v[172:175], v[96:99]
    buffer_load_dwordx4 v[216:219], v15, s[4:7], s37 offen offset:0 sc1
    s_waitcnt vmcnt(7)
    s_add_u32 s54, s50, 8
    s_mov_b32 s38, 1
    s_atomic_add s38, s[14:15], s54
    s_waitcnt lgkmcnt(4)
    v_mfma_f32_16x16x32_bf16 v[36:39], v[104:107], v[168:171], v[36:39]
    ds_read_b128 v[100:103], v32 offset:8192
    v_mfma_f32_16x16x32_bf16 v[40:43], v[104:107], v[172:175], v[40:43]
    v_mfma_f32_16x16x32_bf16 v[44:47], v[108:111], v[168:171], v[44:47]
    ds_read_b128 v[104:107], v32 offset:9216
    v_mfma_f32_16x16x32_bf16 v[48:51], v[108:111], v[172:175], v[48:51]
    buffer_load_dwordx4 v[220:223], v15, s[4:7], s37 offen offset:256 sc1
    s_add_u32 s37, s37, 4096
    s_waitcnt lgkmcnt(4)
    v_mfma_f32_16x16x32_bf16 v[84:87], v[112:115], v[176:179], v[84:87]
    ds_read_b128 v[108:111], v35 offset:8192
    v_mfma_f32_16x16x32_bf16 v[88:91], v[112:115], v[180:183], v[88:91]
    v_mfma_f32_16x16x32_bf16 v[92:95], v[116:119], v[176:179], v[92:95]
    ds_read_b128 v[112:115], v35 offset:9216
    v_mfma_f32_16x16x32_bf16 v[96:99], v[116:119], v[180:183], v[96:99]
    buffer_load_dwordx4 v[224:227], v15, s[4:7], s37 offen offset:0 sc1
    s_add_u32 s28, s52, 4
    s_mov_b32 s55, 0
    s_atomic_add s55, s[14:15], s28 glc
    s_waitcnt lgkmcnt(4)
    v_mfma_f32_16x16x32_bf16 v[36:39], v[120:123], v[176:179], v[36:39]
    ds_read_b128 v[116:119], v32 offset:16384
    v_mfma_f32_16x16x32_bf16 v[40:43], v[120:123], v[180:183], v[40:43]
    v_mfma_f32_16x16x32_bf16 v[44:47], v[124:127], v[176:179], v[44:47]
    ds_read_b128 v[120:123], v32 offset:17408
    v_mfma_f32_16x16x32_bf16 v[48:51], v[124:127], v[180:183], v[48:51]
    buffer_load_dwordx4 v[228:231], v15, s[4:7], s37 offen offset:256 sc1
    s_add_u32 s37, s37, 4096
    s_waitcnt lgkmcnt(4)
    v_mfma_f32_16x16x32_bf16 v[84:87], v[100:103], v[184:187], v[84:87]
    ds_read_b128 v[124:127], v35 offset:16384
    v_mfma_f32_16x16x32_bf16 v[88:91], v[100:103], v[188:191], v[88:91]
    v_mfma_f32_16x16x32_bf16 v[92:95], v[104:107], v[184:187], v[92:95]
    ds_read_b128 v[100:103], v35 offset:17408
    v_mfma_f32_16x16x32_bf16 v[96:99], v[104:107], v[188:191], v[96:99]
    buffer_load_dwordx4 v[232:235], v15, s[4:7], s37 offen offset:0 sc1
    s_waitcnt lgkmcnt(4)
    v_mfma_f32_16x16x32_bf16 v[36:39], v[108:111], v[184:187], v[36:39]
    ds_read_b128 v[104:107], v32 offset:24576
    v_mfma_f32_16x16x32_bf16 v[40:43], v[108:111], v[188:191], v[40:43]
    v_mfma_f32_16x16x32_bf16 v[44:47], v[112:115], v[184:187], v[44:47]
    ds_read_b128 v[108:111], v32 offset:25600
    v_mfma_f32_16x16x32_bf16 v[48:51], v[112:115], v[188:191], v[48:51]
    buffer_load_dwordx4 v[236:239], v15, s[4:7], s37 offen offset:256 sc1
    s_add_u32 s37, s37, 4096
    s_barrier
    s_waitcnt lgkmcnt(4)
    s_waitcnt vmcnt(10)
    v_mfma_f32_16x16x32_bf16 v[84:87], v[116:119], v[192:195], v[84:87]
    ds_read_b128 v[112:115], v35 offset:24576
    v_mfma_f32_16x16x32_bf16 v[88:91], v[116:119], v[196:199], v[88:91]
    v_mfma_f32_16x16x32_bf16 v[92:95], v[120:123], v[192:195], v[92:95]
    ds_read_b128 v[116:119], v35 offset:25600
    v_mfma_f32_16x16x32_bf16 v[96:99], v[120:123], v[196:199], v[96:99]
    buffer_load_dwordx4 v[240:243], v15, s[4:7], s37 offen offset:0 sc1
    s_waitcnt lgkmcnt(4)
    v_mfma_f32_16x16x32_bf16 v[36:39], v[124:127], v[192:195], v[36:39]
    ds_read_b128 v[120:123], v30 offset:0
    v_mfma_f32_16x16x32_bf16 v[40:43], v[124:127], v[196:199], v[40:43]
    v_mfma_f32_16x16x32_bf16 v[44:47], v[100:103], v[192:195], v[44:47]
    ds_read_b128 v[124:127], v30 offset:1024
    v_mfma_f32_16x16x32_bf16 v[48:51], v[100:103], v[196:199], v[48:51]
    buffer_load_dwordx4 v[244:247], v15, s[4:7], s37 offen offset:256 sc1
    s_add_u32 s37, s37, 4096
    s_waitcnt lgkmcnt(4)
    s_waitcnt vmcnt(10)
    v_mfma_f32_16x16x32_bf16 v[84:87], v[104:107], v[200:203], v[84:87]
    ds_read_b128 v[100:103], v33 offset:0
    v_mfma_f32_16x16x32_bf16 v[88:91], v[104:107], v[204:207], v[88:91]
    v_mfma_f32_16x16x32_bf16 v[92:95], v[108:111], v[200:203], v[92:95]
    ds_read_b128 v[104:107], v33 offset:1024
    v_mfma_f32_16x16x32_bf16 v[96:99], v[108:111], v[204:207], v[96:99]
    buffer_load_dwordx4 v[248:251], v15, s[4:7], s37 offen offset:0 sc1
    s_waitcnt lgkmcnt(4)
    v_mfma_f32_16x16x32_bf16 v[36:39], v[112:115], v[200:203], v[36:39]
    ds_read_b128 v[108:111], v30 offset:8192
    v_mfma_f32_16x16x32_bf16 v[40:43], v[112:115], v[204:207], v[40:43]
    v_mfma_f32_16x16x32_bf16 v[44:47], v[116:119], v[200:203], v[44:47]
    ds_read_b128 v[112:115], v30 offset:9216
    v_mfma_f32_16x16x32_bf16 v[48:51], v[116:119], v[204:207], v[48:51]
    buffer_load_dwordx4 v[252:255], v15, s[4:7], s37 offen offset:256 sc1
    s_add_u32 s37, s37, 4096
    s_waitcnt lgkmcnt(4)
    s_waitcnt vmcnt(10)
    v_mfma_f32_16x16x32_bf16 v[84:87], v[120:123], v[208:211], v[84:87]
    ds_read_b128 v[116:119], v33 offset:8192
    v_mfma_f32_16x16x32_bf16 v[88:91], v[120:123], v[212:215], v[88:91]
    v_mfma_f32_16x16x32_bf16 v[92:95], v[124:127], v[208:211], v[92:95]
    ds_read_b128 v[120:123], v33 offset:9216
    v_mfma_f32_16x16x32_bf16 v[96:99], v[124:127], v[212:215], v[96:99]
    s_waitcnt lgkmcnt(4)
    v_mfma_f32_16x16x32_bf16 v[36:39], v[100:103], v[208:211], v[36:39]
    ds_read_b128 v[124:127], v30 offset:16384
    v_mfma_f32_16x16x32_bf16 v[40:43], v[100:103], v[212:215], v[40:43]
    v_mfma_f32_16x16x32_bf16 v[44:47], v[104:107], v[208:211], v[44:47]
    ds_read_b128 v[100:103], v30 offset:17408
    v_mfma_f32_16x16x32_bf16 v[48:51], v[104:107], v[212:215], v[48:51]
    s_barrier
    s_waitcnt lgkmcnt(4)
    s_waitcnt vmcnt(8)
    v_mfma_f32_16x16x32_bf16 v[84:87], v[108:111], v[216:219], v[84:87]
    ds_read_b128 v[104:107], v33 offset:16384
    v_mfma_f32_16x16x32_bf16 v[88:91], v[108:111], v[220:223], v[88:91]
    v_mfma_f32_16x16x32_bf16 v[92:95], v[112:115], v[216:219], v[92:95]
    ds_read_b128 v[108:111], v33 offset:17408
    v_mfma_f32_16x16x32_bf16 v[96:99], v[112:115], v[220:223], v[96:99]
    s_waitcnt lgkmcnt(4)
    v_mfma_f32_16x16x32_bf16 v[36:39], v[116:119], v[216:219], v[36:39]
    ds_read_b128 v[112:115], v30 offset:24576
    v_mfma_f32_16x16x32_bf16 v[40:43], v[116:119], v[220:223], v[40:43]
    v_mfma_f32_16x16x32_bf16 v[44:47], v[120:123], v[216:219], v[44:47]
    ds_read_b128 v[116:119], v30 offset:25600
    v_mfma_f32_16x16x32_bf16 v[48:51], v[120:123], v[220:223], v[48:51]
    s_waitcnt lgkmcnt(0)
    s_cmp_ge_u32 s55, 16
    s_cbranch_scc1 L_go_61
    s_mov_b32 s39, 1048576
L_poll_62:
    s_mov_b32 s49, 0
    s_atomic_add s49, s[14:15], s28 glc
    s_sub_u32 s39, s39, 1
    s_waitcnt lgkmcnt(0)
    s_cmp_ge_u32 s49, 16
    s_cbranch_scc1 L_pok_63
    s_sleep 1
    s_cmp_lg_u32 s39, 0
    s_cbranch_scc1 L_poll_62
L_pok_63:
L_go_61:
    s_waitcnt lgkmcnt(4)
    s_waitcnt vmcnt(6)
    v_mfma_f32_16x16x32_bf16 v[84:87], v[124:127], v[224:227], v[84:87]
    ds_read_b128 v[120:123], v33 offset:24576
    v_mfma_f32_16x16x32_bf16 v[88:91], v[124:127], v[228:231], v[88:91]
    buffer_load_dwordx4 v[128:131], v15, s[4:7], s37 offen offset:0 sc1
    v_mfma_f32_16x16x32_bf16 v[92:95], v[100:103], v[224:227], v[92:95]
    ds_read_b128 v[124:127], v33 offset:25600
    v_mfma_f32_16x16x32_bf16 v[96:99], v[100:103], v[228:231], v[96:99]
    buffer_load_dwordx4 v[132:135], v15, s[4:7], s37 offen offset:256 sc1
    s_add_u32 s37, s37, 4096
    s_add_u32 s28, s52, 8
    s_mov_b32 s55, 0
    s_atomic_add s55, s[14:15], s28 glc
    s_waitcnt lgkmcnt(4)
    v_mfma_f32_16x16x32_bf16 v[36:39], v[104:107], v[224:227], v[36:39]
    ds_read_b128 v[100:103], v30 offset:32768
    v_mfma_f32_16x16x32_bf16 v[40:43], v[104:107], v[228:231], v[40:43]
    buffer_load_dwordx4 v[136:139], v15, s[4:7], s37 offen offset:0 sc1
    v_mfma_f32_16x16x32_bf16 v[44:47], v[108:111], v[224:227], v[44:47]
    ds_read_b128 v[104:107], v30 offset:33792
    v_mfma_f32_16x16x32_bf16 v[48:51], v[108:111], v[228:231], v[48:51]
    buffer_load_dwordx4 v[140:143], v15, s[4:7], s37 offen offset:256 sc1
    s_add_u32 s37, s37, 4096
    s_waitcnt lgkmcnt(4)
    s_waitcnt vmcnt(8)
    v_mfma_f32_16x16x32_bf16 v[84:87], v[112:115], v[232:235], v[84:87]
    ds_read_b128 v[108:111], v33 offset:32768
    v_mfma_f32_16x16x32_bf16 v[88:91], v[112:115], v[236:239], v[88:91]
    buffer_load_dwordx4 v[144:147], v15, s[4:7], s37 offen offset:0 sc1
    v_mfma_f32_16x16x32_bf16 v[92:95], v[116:119], v[232:235], v[92:95]
    ds_read_b128 v[112:115], v33 offset:33792
    v_mfma_f32_16x16x32_bf16 v[96:99], v[116:119], v[236:239], v[96:99]
    buffer_load_dwordx4 v[148:151], v15, s[4:7], s37 offen offset:256 sc1
    s_add_u32 s37, s37, 4096
    s_waitcnt lgkmcnt(4)
    v_mfma_f32_16x16x32_bf16 v[36:39], v[120:123], v[232:235], v[36:39]
    ds_read_b128 v[116:119], v30 offset:40960
    v_mfma_f32_16x16x32_bf16 v[40:43], v[120:123], v[236:239], v[40:43]
    buffer_load_dwordx4 v[152:155], v15, s[4:7], s37 offen offset:0 sc1
    v_mfma_f32_16x16x32_bf16 v[44:47], v[124:127], v[232:235], v[44:47]
    ds_read_b128 v[120:123], v30 offset:41984
    v_mfma_f32_16x16x32_bf16 v[48:51], v[124:127], v[236:239], v[48:51]
    buffer_load_dwordx4 v[156:159], v15, s[4:7], s37 offen offset:256 sc1
    s_add_u32 s37, s37, 4096
    s_barrier
    s_waitcnt lgkmcnt(4)
    s_waitcnt vmcnt(10)
    v_mfma_f32_16x16x32_bf16 v[84:87], v[100:103], v[240:243], v[84:87]
    ds_read_b128 v[124:127], v33 offset:40960
    v_mfma_f32_16x16x32_bf16 v[88:91], v[100:103], v[244:247], v[88:91]
    v_mfma_f32_16x16x32_bf16 v[92:95], v[104:107], v[240:243], v[92:95]
    ds_read_b128 v[100:103], v33 offset:41984
    v_mfma_f32_16x16x32_bf16 v[96:99], v[104:107], v[244:247], v[96:99]
    buffer_load_dwordx4 v[160:163], v15, s[4:7], s37 offen offset:0 sc1
    s_waitcnt lgkmcnt(4)
    v_mfma_f32_16x16x32_bf16 v[36:39], v[108:111], v[240:243], v[36:39]
    ds_read_b128 v[104:107], v30 offset:49152
    v_mfma_f32_16x16x32_bf16 v[40:43], v[108:111], v[244:247], v[40:43]
    v_mfma_f32_16x16x32_bf16 v[44:47], v[112:115], v[240:243], v[44:47]
    ds_read_b128 v[108:111], v30 offset:50176
    v_mfma_f32_16x16x32_bf16 v[48:51], v[112:115], v[244:247], v[48:51]
    buffer_load_dwordx4 v[164:167], v15, s[4:7], s37 offen offset:256 sc1
    s_add_u32 s37, s37, 4096
    s_waitcnt lgkmcnt(4)
    s_waitcnt vmcnt(10)
    v_mfma_f32_16x16x32_bf16 v[84:87], v[116:119], v[248:251], v[84:87]
    ds_read_b128 v[112:115], v33 offset:49152
    v_mfma_f32_16x16x32_bf16 v[88:91], v[116:119], v[252:255], v[88:91]
    v_mfma_f32_16x16x32_bf16 v[92:95], v[120:123], v[248:251], v[92:95]
    ds_read_b128 v[116:119], v33 offset:50176
    v_mfma_f32_16x16x32_bf16 v[96:99], v[120:123], v[252:255], v[96:99]
    buffer_load_dwordx4 v[168:171], v15, s[4:7], s37 offen offset:0 sc1
    s_waitcnt lgkmcnt(4)
    v_mfma_f32_16x16x32_bf16 v[36:39], v[124:127], v[248:251], v[36:39]
    ds_read_b128 v[120:123], v30 offset:57344
    v_mfma_f32_16x16x32_bf16 v[40:43], v[124:127], v[252:255], v[40:43]
    v_mfma_f32_16x16x32_bf16 v[44:47], v[100:103], v[248:251], v[44:47]
    ds_read_b128 v[124:127], v30 offset:58368
    v_mfma_f32_16x16x32_bf16 v[48:51], v[100:103], v[252:255], v[48:51]
    buffer_load_dwordx4 v[172:175], v15, s[4:7], s37 offen offset:256 sc1
    s_add_u32 s37, s37, 4096
    s_waitcnt lgkmcnt(4)
    s_waitcnt vmcnt(10)
    v_mfma_f32_16x16x32_bf16 v[84:87], v[104:107], v[128:131], v[84:87]
    ds_read_b128 v[100:103], v33 offset:57344
    v_mfma_f32_16x16x32_bf16 v[88:91], v[104:107], v[132:135], v[88:91]
    v_mfma_f32_16x16x32_bf16 v[92:95], v[108:111], v[128:131], v[92:95]
    ds_read_b128 v[104:107], v33 offset:58368
    v_mfma_f32_16x16x32_bf16 v[96:99], v[108:111], v[132:135], v[96:99]
    buffer_load_dwordx4 v[176:179], v15, s[4:7], s37 offen offset:0 sc1
    s_waitcnt lgkmcnt(4)
    v_mfma_f32_16x16x32_bf16 v[36:39], v[112:115], v[128:131], v[36:39]
    ds_read_b128 v[108:111], v31 offset:0
    v_mfma_f32_16x16x32_bf16 v[40:43], v[112:115], v[132:135], v[40:43]
    v_mfma_f32_16x16x32_bf16 v[44:47], v[116:119], v[128:131], v[44:47]
    ds_read_b128 v[112:115], v31 offset:1024
    v_mfma_f32_16x16x32_bf16 v[48:51], v[116:119], v[132:135], v[48:51]
    buffer_load_dwordx4 v[180:183], v15, s[4:7], s37 offen offset:256 sc1
    s_add_u32 s37, s37, 4096
    s_barrier
    s_waitcnt lgkmcnt(4)
    s_waitcnt vmcnt(10)
    v_mfma_f32_16x16x32_bf16 v[84:87], v[120:123], v[136:139], v[84:87]
    ds_read_b128 v[116:119], v34 offset:0
    v_mfma_f32_16x16x32_bf16 v[88:91], v[120:123], v[140:143], v[88:91]
    v_mfma_f32_16x16x32_bf16 v[92:95], v[124:127], v[136:139], v[92:95]
    ds_read_b128 v[120:123], v34 offset:1024
    v_mfma_f32_16x16x32_bf16 v[96:99], v[124:127], v[140:143], v[96:99]
    buffer_load_dwordx4 v[184:187], v15, s[4:7], s37 offen offset:0 sc1
    s_waitcnt lgkmcnt(4)
    v_mfma_f32_16x16x32_bf16 v[36:39], v[100:103], v[136:139], v[36:39]
    ds_read_b128 v[124:127], v31 offset:8192
    v_mfma_f32_16x16x32_bf16 v[40:43], v[100:103], v[140:143], v[40:43]
    v_mfma_f32_16x16x32_bf16 v[44:47], v[104:107], v[136:139], v[44:47]
    ds_read_b128 v[100:103], v31 offset:9216
    v_mfma_f32_16x16x32_bf16 v[48:51], v[104:107], v[140:143], v[48:51]
    buffer_load_dwordx4 v[188:191], v15, s[4:7], s37 offen offset:256 sc1
    s_add_u32 s37, s37, 4096
    s_waitcnt lgkmcnt(0)
    s_cmp_ge_u32 s55, 16
    s_cbranch_scc1 L_go_64
    s_mov_b32 s39, 1048576
L_poll_65:
    s_mov_b32 s49, 0
    s_atomic_add s49, s[14:15], s28 glc
    s_sub_u32 s39, s39, 1
    s_waitcnt lgkmcnt(0)
    s_cmp_ge_u32 s49, 16
    s_cbranch_scc1 L_pok_66
    s_sleep 1
    s_cmp_lg_u32 s39, 0
    s_cbranch_scc1 L_poll_65
L_pok_66:
L_go_64:
    s_waitcnt lgkmcnt(4)
    s_waitcnt vmcnt(10)
    v_mfma_f32_16x16x32_bf16 v[84:87], v[108:111], v[144:147], v[84:87]
    ds_read_b128 v[104:107], v34 offset:8192
    v_mfma_f32_16x16x32_bf16 v[88:91], v[108:111], v[148:151], v[88:91]
    v_mfma_f32_16x16x32_bf16 v[92:95], v[112:115], v[144:147], v[92:95]
    ds_read_b128 v[108:111], v34 offset:9216
    v_mfma_f32_16x16x32_bf16 v[96:99], v[112:115], v[148:151], v[96:99]
    buffer_load_dwordx4 v[192:195], v15, s[4:7], s37 offen offset:0 sc1
    s_waitcnt lgkmcnt(4)
    v_mfma_f32_16x16x32_bf16 v[36:39], v[116:119], v[144:147], v[36:39]
    ds_read_b128 v[112:115], v31 offset:16384
    v_mfma_f32_16x16x32_bf16 v[40:43], v[116:119], v[148:151], v[40:43]
    v_mfma_f32_16x16x32_bf16 v[44:47], v[120:123], v[144:147], v[44:47]
    ds_read_b128 v[116:119], v31 offset:17408
    v_mfma_f32_16x16x32_bf16 v[48:51], v[120:123], v[148:151], v[48:51]
    buffer_load_dwordx4 v[196:199], v15, s[4:7], s37 offen offset:256 sc1
    s_add_u32 s37, s37, 4096
    s_waitcnt lgkmcnt(4)
    s_waitcnt vmcnt(10)
    v_mfma_f32_16x16x32_bf16 v[84:87], v[124:127], v[152:155], v[84:87]
    ds_read_b128 v[120:123], v34 offset:16384
    v_mfma_f32_16x16x32_bf16 v[88:91], v[124:127], v[156:159], v[88:91]
    v_mfma_f32_16x16x32_bf16 v[92:95], v[100:103], v[152:155], v[92:95]
    ds_read_b128 v[124:127], v34 offset:17408
    v_mfma_f32_16x16x32_bf16 v[96:99], v[100:103], v[156:159], v[96:99]
    buffer_load_dwordx4 v[200:203], v15, s[4:7], s37 offen offset:0 sc1
    s_waitcnt lgkmcnt(4)
    v_mfma_f32_16x16x32_bf16 v[36:39], v[104:107], v[152:155], v[36:39]
    ds_read_b128 v[100:103], v31 offset:24576
    v_mfma_f32_16x16x32_bf16 v[40:43], v[104:107], v[156:159], v[40:43]
    v_mfma_f32_16x16x32_bf16 v[44:47], v[108:111], v[152:155], v[44:47]
    ds_read_b128 v[104:107], v31 offset:25600
    v_mfma_f32_16x16x32_bf16 v[48:51], v[108:111], v[156:159], v[48:51]
    buffer_load_dwordx4 v[204:207], v15, s[4:7], s37 offen offset:256 sc1
    s_add_u32 s37, s37, 4096
    s_waitcnt lgkmcnt(4)
    s_waitcnt vmcnt(10)
    v_mfma_f32_16x16x32_bf16 v[84:87], v[112:115], v[160:163], v[84:87]
    ds_read_b128 v[108:111], v34 offset:24576
    v_mfma_f32_16x16x32_bf16 v[88:91], v[112:115], v[164:167], v[88:91]
    v_mfma_f32_16x16x32_bf16 v[92:95], v[116:119], v[160:163], v[92:95]
    ds_read_b128 v[112:115], v34 offset:25600
    v_mfma_f32_16x16x32_bf16 v[96:99], v[116:119], v[164:167], v[96:99]
    buffer_load_dwordx4 v[208:211], v15, s[4:7], s37 offen offset:0 sc1
    s_waitcnt lgkmcnt(4)
    v_mfma_f32_16x16x32_bf16 v[36:39], v[120:123], v[160:163], v[36:39]
    ds_read_b128 v[116:119], v31 offset:32768
    v_mfma_f32_16x16x32_bf16 v[40:43], v[120:123], v[164:167], v[40:43]
    v_mfma_f32_16x16x32_bf16 v[44:47], v[124:127], v[160:163], v[44:47]
    ds_read_b128 v[120:123], v31 offset:33792
    v_mfma_f32_16x16x32_bf16 v[48:51], v[124:127], v[164:167], v[48:51]
    buffer_load_dwordx4 v[212:215], v15, s[4:7], s37 offen offset:256 sc1
    s_add_u32 s37, s37, 4096
    s_waitcnt lgkmcnt(4)
    s_waitcnt vmcnt(10)
    v_mfma_f32_16x16x32_bf16 v[84:87], v[100:103], v[168:171], v[84:87]
    ds_read_b128 v[124:127], v34 offset:32768
    v_mfma_f32_16x16x32_bf16 v[88:91], v[100:103], v[172:175], v[88:91]
    v_mfma_f32_16x16x32_bf16 v[92:95], v[104:107], v[168:171], v[92:95]
    ds_read_b128 v[100:103], v34 offset:33792
    v_mfma_f32_16x16x32_bf16 v[96:99], v[104:107], v[172:175], v[96:99]
    buffer_load_dwordx4 v[216:219], v15, s[4:7], s37 offen offset:0 sc1
    s_waitcnt lgkmcnt(4)
    v_mfma_f32_16x16x32_bf16 v[36:39], v[108:111], v[168:171], v[36:39]
    ds_read_b128 v[104:107], v31 offset:40960
    v_mfma_f32_16x16x32_bf16 v[40:43], v[108:111], v[172:175], v[40:43]
    v_mfma_f32_16x16x32_bf16 v[44:47], v[112:115], v[168:171], v[44:47]
    ds_read_b128 v[108:111], v31 offset:41984
    v_mfma_f32_16x16x32_bf16 v[48:51], v[112:115], v[172:175], v[48:51]
    buffer_load_dwordx4 v[220:223], v15, s[4:7], s37 offen offset:256 sc1
    s_add_u32 s37, s37, 4096
    s_barrier
    s_waitcnt lgkmcnt(4)
    s_waitcnt vmcnt(10)
    v_mfma_f32_16x16x32_bf16 v[84:87], v[116:119], v[176:179], v[84:87]
    ds_read_b128 v[112:115], v34 offset:40960
    v_mfma_f32_16x16x32_bf16 v[88:91], v[116:119], v[180:183], v[88:91]
    v_mfma_f32_16x16x32_bf16 v[92:95], v[120:123], v[176:179], v[92:95]
    ds_read_b128 v[116:119], v34 offset:41984
    v_mfma_f32_16x16x32_bf16 v[96:99], v[120:123], v[180:183], v[96:99]
    s_waitcnt lgkmcnt(4)
    v_mfma_f32_16x16x32_bf16 v[36:39], v[124:127], v[176:179], v[36:39]
    ds_read_b128 v[120:123], v34 offset:49152
    v_mfma_f32_16x16x32_bf16 v[40:43], v[124:127], v[180:183], v[40:43]
    v_mfma_f32_16x16x32_bf16 v[44:47], v[100:103], v[176:179], v[44:47]
    ds_read_b128 v[124:127], v34 offset:50176
    v_mfma_f32_16x16x32_bf16 v[48:51], v[100:103], v[180:183], v[48:51]
    s_waitcnt lgkmcnt(4)
    s_waitcnt vmcnt(8)
    v_mfma_f32_16x16x32_bf16 v[84:87], v[104:107], v[184:187], v[84:87]
    ds_read_b128 v[100:103], v34 offset:57344
    v_mfma_f32_16x16x32_bf16 v[88:91], v[104:107], v[188:191], v[88:91]
    v_mfma_f32_16x16x32_bf16 v[92:95], v[108:111], v[184:187], v[92:95]
    ds_read_b128 v[104:107], v34 offset:58368
    v_mfma_f32_16x16x32_bf16 v[96:99], v[108:111], v[188:191], v[96:99]
    s_waitcnt lgkmcnt(4)
    v_mfma_f32_16x16x32_bf16 v[36:39], v[112:115], v[184:187], v[36:39]
    ds_read_b128 v[108:111], v35 offset:0
    v_mfma_f32_16x16x32_bf16 v[40:43], v[112:115], v[188:191], v[40:43]
    v_mfma_f32_16x16x32_bf16 v[44:47], v[116:119], v[184:187], v[44:47]
    ds_read_b128 v[112:115], v35 offset:1024
    v_mfma_f32_16x16x32_bf16 v[48:51], v[116:119], v[188:191], v[48:51]
    s_waitcnt lgkmcnt(4)
    s_waitcnt vmcnt(6)
    v_mfma_f32_16x16x32_bf16 v[36:39], v[120:123], v[192:195], v[36:39]
    s_lshl_b32 s26, s16, 12
    ds_read_b128 v[116:119], v35 offset:8192
    v_mfma_f32_16x16x32_bf16 v[40:43], v[120:123], v[196:199], v[40:43]
    s_add_u32 s26, s26, 81920
    v_mfma_f32_16x16x32_bf16 v[44:47], v[124:127], v[192:195], v[44:47]
    s_xor_b32 s27, s26, 0x2000
    ds_read_b128 v[120:123], v35 offset:9216
    v_mfma_f32_16x16x32_bf16 v[48:51], v[124:127], v[196:199], v[48:51]
    v_add_u32 v28, s26, v2
    s_waitcnt lgkmcnt(4)
    s_waitcnt vmcnt(4)
    v_mfma_f32_16x16x32_bf16 v[36:39], v[100:103], v[200:203], v[36:39]
    v_add_u32 v29, s27, v2
    ds_read_b128 v[124:127], v31 offset:49152
    v_mfma_f32_16x16x32_bf16 v[40:43], v[100:103], v[204:207], v[40:43]
    v_mfma_f32_16x16x32_bf16 v[44:47], v[104:107], v[200:203], v[44:47]
    ds_read_b128 v[100:103], v31 offset:50176
    v_mfma_f32_16x16x32_bf16 v[48:51], v[104:107], v[204:207], v[48:51]
    s_waitcnt lgkmcnt(4)
    s_waitcnt vmcnt(2)
    v_mfma_f32_16x16x32_bf16 v[36:39], v[108:111], v[208:211], v[36:39]
    ds_read_b128 v[104:107], v31 offset:57344
    v_mfma_f32_16x16x32_bf16 v[40:43], v[108:111], v[212:215], v[40:43]
    v_mfma_f32_16x16x32_bf16 v[44:47], v[112:115], v[208:211], v[44:47]
    ds_read_b128 v[108:111], v31 offset:58368
    v_mfma_f32_16x16x32_bf16 v[48:51], v[112:115], v[212:215], v[48:51]
    s_waitcnt lgkmcnt(4)
    s_waitcnt vmcnt(0)
    v_mfma_f32_16x16x32_bf16 v[36:39], v[116:119], v[216:219], v[36:39]
    ds_read_b128 v[112:115], v32 offset:0
    v_mfma_f32_16x16x32_bf16 v[40:43], v[116:119], v[220:223], v[40:43]
    v_mfma_f32_16x16x32_bf16 v[44:47], v[120:123], v[216:219], v[44:47]
    ds_read_b128 v[116:119], v32 offset:1024
    v_mfma_f32_16x16x32_bf16 v[48:51], v[120:123], v[220:223], v[48:51]
    s_waitcnt lgkmcnt(4)
    v_mfma_f32_16x16x32_bf16 v[84:87], v[124:127], v[192:195], v[84:87]
    ds_read_b128 v[120:123], v32 offset:8192
    v_mfma_f32_16x16x32_bf16 v[88:91], v[124:127], v[196:199], v[88:91]
    v_mfma_f32_16x16x32_bf16 v[92:95], v[100:103], v[192:195], v[92:95]
    ds_read_b128 v[124:127], v32 offset:9216
    v_mfma_f32_16x16x32_bf16 v[96:99], v[100:103], v[196:199], v[96:99]
    s_waitcnt lgkmcnt(4)
    v_mfma_f32_16x16x32_bf16 v[84:87], v[104:107], v[200:203], v[84:87]
    ds_write_b128 v28, v[36:39] offset:0
    v_mfma_f32_16x16x32_bf16 v[88:91], v[104:107], v[204:207], v[88:91]
    ds_write_b128 v28, v[40:43] offset:1024
    v_mfma_f32_16x16x32_bf16 v[92:95], v[108:111], v[200:203], v[92:95]
    ds_write_b128 v28, v[44:47] offset:2048
    v_mfma_f32_16x16x32_bf16 v[96:99], v[108:111], v[204:207], v[96:99]
    ds_write_b128 v28, v[48:51] offset:3072
    s_waitcnt lgkmcnt(6)
    v_mfma_f32_16x16x32_bf16 v[84:87], v[112:115], v[208:211], v[84:87]
    v_mfma_f32_16x16x32_bf16 v[88:91], v[112:115], v[212:215], v[88:91]
    v_mfma_f32_16x16x32_bf16 v[92:95], v[116:119], v[208:211], v[92:95]
    v_mfma_f32_16x16x32_bf16 v[96:99], v[116:119], v[212:215], v[96:99]
    s_waitcnt lgkmcnt(4)
    s_waitcnt lgkmcnt(0)
    s_barrier
    ds_read_b128 v[36:39], v29 offset:0
    ds_read_b128 v[40:43], v29 offset:1024
    ds_read_b128 v[44:47], v29 offset:2048
    ds_read_b128 v[48:51], v29 offset:3072
    v_mfma_f32_16x16x32_bf16 v[84:87], v[120:123], v[216:219], v[84:87]
    v_mfma_f32_16x16x32_bf16 v[88:91], v[120:123], v[220:223], v[88:91]
    v_mfma_f32_16x16x32_bf16 v[92:95], v[124:127], v[216:219], v[92:95]
    v_mfma_f32_16x16x32_bf16 v[96:99], v[124:127], v[220:223], v[96:99]
    s_setprio 0
    s_lshl_b32 s26, s31, 15
    s_lshl_b32 s27, s33, 11
    s_add_u32 s26, s26, s27
    s_add_u32 s26, s26, s41
    s_add_u32 s26, s26, 0x1e00000
    s_lshl_b32 s28, s31, 12
    s_lshl_b32 s29, s33, 8
    s_add_u32 s28, s28, s29
    s_waitcnt lgkmcnt(0)
    v_pk_add_f32 v[84:85], v[84:85], v[36:37]
    v_pk_add_f32 v[86:87], v[86:87], v[38:39]
    v_pk_add_f32 v[88:89], v[88:89], v[40:41]
    v_pk_add_f32 v[90:91], v[90:91], v[42:43]
    v_pk_add_f32 v[92:93], v[92:93], v[44:45]
    v_pk_add_f32 v[94:95], v[94:95], v[46:47]
    v_pk_add_f32 v[96:97], v[96:97], v[48:49]
    v_pk_add_f32 v[98:99], v[98:99], v[50:51]
    v_cvt_pk_bf16_f32 v4, v84, v85
    v_cvt_pk_bf16_f32 v5, v86, v87
    v_cvt_pk_bf16_f32 v6, v92, v93
    v_cvt_pk_bf16_f32 v7, v94, v95
    v_cvt_pk_bf16_f32 v8, v88, v89
    v_cvt_pk_bf16_f32 v9, v90, v91
    v_cvt_pk_bf16_f32 v10, v96, v97
    v_cvt_pk_bf16_f32 v11, v98, v99
    s_cmp_eq_u32 s40, 1
    s_cbranch_scc1 L_final_67
    buffer_store_dwordx4 v[4:7], v15, s[4:7], s26 offen sc1
    buffer_store_dwordx4 v[8:11], v15, s[4:7], s26 offen offset:256 sc1
    v_pk_mul_f32 v[240:241], v[84:85], v[84:85]
    v_pk_mul_f32 v[242:243], v[88:89], v[88:89]
    v_pk_fma_f32 v[240:241], v[86:87], v[86:87], v[240:241]
    v_pk_add_f32 v[84:85], v[84:85], v[86:87]
    v_pk_fma_f32 v[242:243], v[90:91], v[90:91], v[242:243]
    v_pk_add_f32 v[88:89], v[88:89], v[90:91]
    v_pk_fma_f32 v[240:241], v[92:93], v[92:93], v[240:241]
    v_pk_add_f32 v[84:85], v[84:85], v[92:93]
    v_pk_fma_f32 v[242:243], v[96:97], v[96:97], v[242:243]
    v_pk_add_f32 v[88:89], v[88:89], v[96:97]
    v_pk_fma_f32 v[240:241], v[94:95], v[94:95], v[240:241]
    v_pk_add_f32 v[84:85], v[84:85], v[94:95]
    v_pk_fma_f32 v[242:243], v[98:99], v[98:99], v[242:243]
    v_pk_add_f32 v[88:89], v[88:89], v[98:99]
    v_add_f32 v244, v84, v85
    v_add_f32 v245, v88, v89
    v_add_f32 v246, v240, v241
    v_add_f32 v247, v242, v243
    v_permlane32_swap_b32 v244, v245
    s_add_u32 s28, s28, s41
    v_permlane32_swap_b32 v246, v247
    v_add_f32 v244, v244, v245
    v_add_f32 v246, v246, v247
    s_add_u32 s28, s28, 0x2740000
    s_nop 0
    v_permlane16_swap_b32 v244, v246
    s_nop 0
    v_add_f32 v244, v244, v246
    buffer_store_dword v244, v3, s[4:7], s28 offen sc1
    s_barrier
    s_branch L_mlp_end_55
L_final_67:
    s_mov_b32 s8, s70
    s_and_b32 s9, s71, 0xffff
    s_mov_b32 s10, 0x200000
    s_mov_b32 s11, 0x20000
    v_and_b32 v240, 15, v0
    v_mul_u32_u24 v240, 144, v240
    v_and_b32 v241, 48, v0
    s_mul_i32 s26, s24, 4608
    s_lshl_b32 s27, s25, 6
    s_add_u32 s26, s26, s27
    s_add_u32 s26, s26, 65536
    v_add3_u32 v240, v240, v241, s26
    ds_write_b128 v240, v[4:7]
    ds_write_b128 v240, v[8:11] offset:2304
    v_lshrrev_b32 v242, 3, v0
    v_and_b32 v243, 0x70, v2
    v_mul_u32_u24 v241, 144, v242
    s_mul_i32 s26, s16, 2304
    s_add_u32 s26, s26, 65536
    v_add3_u32 v241, v241, v243, s26
    v_lshl_add_u32 v242, v242, 10, v243
    s_lshl_b32 s26, s43, 15
    s_lshl_b32 s27, s16, 14
    s_add_u32 s26, s26, s27
    s_lshl_b32 s27, s44, 7
    s_add_u32 s26, s26, s27
    s_add_u32 s27, s26, 8192
    s_waitcnt lgkmcnt(0)
    s_barrier
    ds_read_b128 v[4:7], v241
    ds_read_b128 v[8:11], v241 offset:1152
    s_waitcnt lgkmcnt(1)
    buffer_store_dwordx4 v[4:7], v242, s[8:11], s26 offen sc1
    s_waitcnt lgkmcnt(0)
    buffer_store_dwordx4 v[8:11], v242, s[8:11], s27 offen sc1
L_mlp_end_55:
    s_cmp_eq_u32 s40, 1
    s_cbranch_scc1 L_fin_3
    s_mov_b32 s40, 1
    s_add_u32 s41, s41, 0x1400000
    s_add_u32 s42, s42, 0xc000
    s_cmp_lt_u32 s16, 4
    s_cbranch_scc1 L_qkv_comp_68
    s_and_b32 s19, s16, 3
    s_lshl_b32 s25, s19, 12
    s_mul_i32 s23, s46, 104448
    s_add_u32 s23, s23, s25
    s_add_u32 s26, s25, 0
    s_mov_b32 m0, s26
    s_add_u32 s27, s23, 0
    buffer_load_dwordx4 v2, s[4:7], s27 offen offset:0 sc1 lds
    buffer_load_dwordx4 v2, s[4:7], s27 offen offset:1024 sc1 lds
    buffer_load_dwordx4 v2, s[4:7], s27 offen offset:2048 sc1 lds
    buffer_load_dwordx4 v2, s[4:7], s27 offen offset:3072 sc1 lds
    s_add_u32 s26, s25, 16384
    s_mov_b32 m0, s26
    s_add_u32 s27, s23, 16384
    buffer_load_dwordx4 v2, s[4:7], s27 offen offset:0 sc1 lds
    buffer_load_dwordx4 v2, s[4:7], s27 offen offset:1024 sc1 lds
    buffer_load_dwordx4 v2, s[4:7], s27 offen offset:2048 sc1 lds
    buffer_load_dwordx4 v2, s[4:7], s27 offen offset:3072 sc1 lds
    s_add_u32 s26, s25, 32768
    s_mov_b32 m0, s26
    s_add_u32 s27, s23, 32768
    buffer_load_dwordx4 v2, s[4:7], s27 offen offset:0 sc1 lds
    buffer_load_dwordx4 v2, s[4:7], s27 offen offset:1024 sc1 lds
    buffer_load_dwordx4 v2, s[4:7], s27 offen offset:2048 sc1 lds
    buffer_load_dwordx4 v2, s[4:7], s27 offen offset:3072 sc1 lds
    s_add_u32 s26, s25, 49152
    s_mov_b32 m0, s26
    s_add_u32 s27, s23, 49152
    buffer_load_dwordx4 v2, s[4:7], s27 offen offset:0 sc1 lds
    buffer_load_dwordx4 v2, s[4:7], s27 offen offset:1024 sc1 lds
    buffer_load_dwordx4 v2, s[4:7], s27 offen offset:2048 sc1 lds
    buffer_load_dwordx4 v2, s[4:7], s27 offen offset:3072 sc1 lds
    s_add_u32 s26, s25, 65536
    s_mov_b32 m0, s26
    s_add_u32 s27, s23, 65536
    buffer_load_dwordx4 v2, s[4:7], s27 offen offset:0 sc1 lds
    buffer_load_dwordx4 v2, s[4:7], s27 offen offset:1024 sc1 lds
    buffer_load_dwordx4 v2, s[4:7], s27 offen offset:2048 sc1 lds
    buffer_load_dwordx4 v2, s[4:7], s27 offen offset:3072 sc1 lds
    s_add_u32 s26, s25, 81920
    s_mov_b32 m0, s26
    s_add_u32 s27, s23, 81920
    buffer_load_dwordx4 v2, s[4:7], s27 offen offset:0 sc1 lds
    buffer_load_dwordx4 v2, s[4:7], s27 offen offset:1024 sc1 lds
    buffer_load_dwordx4 v2, s[4:7], s27 offen offset:2048 sc1 lds
    buffer_load_dwordx4 v2, s[4:7], s27 offen offset:3072 sc1 lds
    s_add_u32 s26, s25, 98304
    s_mov_b32 m0, s26
    s_add_u32 s27, s23, 98304
    buffer_load_dwordx4 v2, s[4:7], s27 offen offset:0 sc1 lds
    buffer_load_dwordx4 v2, s[4:7], s27 offen offset:1024 sc1 lds
    buffer_load_dwordx4 v2, s[4:7], s27 offen offset:2048 sc1 lds
    buffer_load_dwordx4 v2, s[4:7], s27 offen offset:3072 sc1 lds
    s_waitcnt vmcnt(20)
    s_barrier
    s_add_u32 s22, s45, s19
    s_lshl_b32 s22, s22, 12
    s_add_u32 s22, s22, s41
    s_add_u32 s22, s22, 0x1340000
    buffer_load_dwordx4 v[32:35], v2, s[4:7], s22 offen offset:0 sc1
    buffer_load_dwordx4 v[36:39], v2, s[4:7], s22 offen offset:1024 sc1
    buffer_load_dwordx4 v[40:43], v2, s[4:7], s22 offen offset:2048 sc1
    buffer_load_dwordx4 v[44:47], v2, s[4:7], s22 offen offset:3072 sc1
    s_waitcnt vmcnt(16)
    s_barrier
    s_waitcnt vmcnt(0)
    v_add_f32 v32, v32, v40
    v_add_f32 v33, v33, v41
    v_add_f32 v34, v34, v42
    v_add_f32 v35, v35, v43
    v_add_f32 v36, v36, v44
    v_add_f32 v37, v37, v45
    v_add_f32 v38, v38, v46
    v_add_f32 v39, v39, v47
    v_add_f32 v32, v32, v36
    v_add_f32 v33, v33, v37
    v_add_f32 v34, v34, v38
    v_add_f32 v35, v35, v39
    s_nop 1
    v_permlane32_swap_b32 v32, v34
    v_permlane32_swap_b32 v33, v35
    v_add_f32 v32, v32, v34
    v_add_f32 v33, v33, v35
    v_mov_b32 v34, v32
    v_mov_b32 v35, v33
    s_nop 1
    v_permlane16_swap_b32 v32, v34
    v_permlane16_swap_b32 v33, v35
    v_add_f32 v32, v32, v34
    v_add_f32 v33, v33, v35
    v_mul_f32 v32, 0xbb000000, v32
    v_mul_f32 v33, 0x3b000000, v33
    v_fma_f32 v33, -v32, v32, v33
    v_max_f32 v33, 0, v33
    v_add_f32 v33, 0x3727c5ac, v33
    v_rsq_f32 v22, v33
    v_cvt_pk_bf16_f32 v20, v32, v32
    v_lshlrev_b32 v34, 16, v20
    v_sub_f32 v34, v32, v34
    v_cvt_pk_bf16_f32 v21, v34, v34
    s_add_u32 s26, s25, 114688
    v_add_u32 v16, s26, v2
    v_add_u32 v17, s26, v1
    v_mul_f32 v23, 0x3eb8aa3b, v22
    ds_write_b128 v16, v[20:23]
    ds_write_b32 v17, v22 offset:1024
    s_waitcnt lgkmcnt(0)
    s_barrier
    s_branch L_qkv_end_69
L_qkv_comp_68:
    s_add_u32 s31, s45, s16
    s_lshl_b32 s22, s31, 15
    v_add_u32 v16, 0, v2
    v_add_u32 v17, 65536, v2
    s_lshl_b32 s26, s16, 12
    s_add_u32 s26, s26, 114688
    v_and_b32 v18, 0xff, v2
    v_add_u32 v18, s26, v18
    v_and_b32 v19, 48, v0
    v_add_u32 v19, s26, v19
    v_mov_b32 v26, 0
    v_mov_b32 v27, 0
    v_lshrrev_b32 v206, 5, v0
    v_and_b32 v207, 0x3ff, v15
    v_lshl_add_u32 v206, v206, 16, v207
    s_add_u32 s22, s22, s41
    s_add_u32 s22, s22, 0xa00000
    s_lshl_b32 s23, s31, 8
    s_add_u32 s23, s23, s42
    s_add_u32 s23, s23, 0xffffc008
    s_waitcnt vmcnt(0)
    s_mov_b32 s38, 1
    s_atomic_add s38, s[14:15], s48
    s_mov_b32 s39, 1048576
L_poll_70:
    s_mov_b32 s49, 0
    s_atomic_add s49, s[14:15], s23 glc
    s_sub_u32 s39, s39, 1
    s_waitcnt lgkmcnt(0)
    s_cmp_ge_u32 s49, 16
    s_cbranch_scc1 L_pok_71
    s_sleep 1
    s_cmp_lg_u32 s39, 0
    s_cbranch_scc1 L_poll_70
L_pok_71:
    buffer_load_dwordx4 v[108:111], v15, s[4:7], s22 offen offset:0 sc1
    buffer_load_dwordx4 v[112:115], v15, s[4:7], s22 offen offset:256 sc1
    buffer_load_dwordx4 v[116:119], v15, s[4:7], s22 offen offset:2048 sc1
    buffer_load_dwordx4 v[120:123], v15, s[4:7], s22 offen offset:2304 sc1
    s_add_u32 s22, s22, 4096
    buffer_load_dwordx4 v[124:127], v15, s[4:7], s22 offen offset:0 sc1
    buffer_load_dwordx4 v[128:131], v15, s[4:7], s22 offen offset:256 sc1
    buffer_load_dwordx4 v[132:135], v15, s[4:7], s22 offen offset:2048 sc1
    buffer_load_dwordx4 v[136:139], v15, s[4:7], s22 offen offset:2304 sc1
    s_add_u32 s22, s22, 4096
    buffer_load_dwordx4 v[140:143], v15, s[4:7], s22 offen offset:0 sc1
    buffer_load_dwordx4 v[144:147], v15, s[4:7], s22 offen offset:256 sc1
    buffer_load_dwordx4 v[148:151], v15, s[4:7], s22 offen offset:2048 sc1
    buffer_load_dwordx4 v[152:155], v15, s[4:7], s22 offen offset:2304 sc1
    s_add_u32 s22, s22, 4096
    s_barrier
    ds_read_b128 v[76:79], v16 offset:0
    ds_read_b128 v[80:83], v16 offset:1024
    ds_read_b128 v[84:87], v16 offset:2048
    ds_read_b128 v[88:91], v16 offset:3072
    ds_read_b128 v[92:95], v16 offset:4096
    ds_read_b128 v[96:99], v16 offset:5120
    s_lshl_b32 s48, s46, 8
    s_add_u32 s48, s48, s42
    s_lshl_b32 s26, s46, 17
    s_lshl_b32 s27, s31, 10
    s_add_u32 s26, s26, s27
    s_add_u32 s26, s26, s41
    s_waitcnt lgkmcnt(4)
    s_waitcnt vmcnt(10)
    v_mfma_f32_16x16x32_bf16 v[28:31], v[76:79], v[108:111], 0
    ds_read_b128 v[100:103], v16 offset:6144
    v_mfma_f32_16x16x32_bf16 v[32:35], v[76:79], v[112:115], 0
    v_mfma_f32_16x16x32_bf16 v[36:39], v[80:83], v[108:111], 0
    ds_read_b128 v[104:107], v16 offset:7168
    v_mfma_f32_16x16x32_bf16 v[40:43], v[80:83], v[112:115], 0
    s_waitcnt lgkmcnt(4)
    v_mfma_f32_16x16x32_bf16 v[44:47], v[84:87], v[108:111], 0
    ds_read_b128 v[76:79], v16 offset:8192
    v_mfma_f32_16x16x32_bf16 v[48:51], v[84:87], v[112:115], 0
    buffer_load_dwordx4 v[156:159], v15, s[4:7], s22 offen offset:0 sc1
    v_mfma_f32_16x16x32_bf16 v[52:55], v[88:91], v[108:111], 0
    ds_read_b128 v[80:83], v16 offset:9216
    v_mfma_f32_16x16x32_bf16 v[56:59], v[88:91], v[112:115], 0
    s_waitcnt lgkmcnt(4)
    v_mfma_f32_16x16x32_bf16 v[60:63], v[108:111], v[92:95], 0
    ds_read_b128 v[84:87], v16 offset:10240
    v_mfma_f32_16x16x32_bf16 v[64:67], v[112:115], v[92:95], 0
    v_mfma_f32_16x16x32_bf16 v[68:71], v[108:111], v[96:99], 0
    ds_read_b128 v[88:91], v16 offset:11264
    v_mfma_f32_16x16x32_bf16 v[72:75], v[112:115], v[96:99], 0
    buffer_load_dwordx4 v[160:163], v15, s[4:7], s22 offen offset:256 sc1
    s_waitcnt lgkmcnt(4)
    s_waitcnt vmcnt(10)
    v_mfma_f32_16x16x32_bf16 v[28:31], v[100:103], v[116:119], v[28:31]
    ds_read_b128 v[92:95], v16 offset:12288
    v_mfma_f32_16x16x32_bf16 v[32:35], v[100:103], v[120:123], v[32:35]
    v_mfma_f32_16x16x32_bf16 v[36:39], v[104:107], v[116:119], v[36:39]
    ds_read_b128 v[96:99], v16 offset:13312
    v_mfma_f32_16x16x32_bf16 v[40:43], v[104:107], v[120:123], v[40:43]
    s_waitcnt lgkmcnt(4)
    v_mfma_f32_16x16x32_bf16 v[44:47], v[76:79], v[116:119], v[44:47]
    ds_read_b128 v[100:103], v16 offset:14336
    v_mfma_f32_16x16x32_bf16 v[48:51], v[76:79], v[120:123], v[48:51]
    buffer_load_dwordx4 v[164:167], v15, s[4:7], s22 offen offset:2048 sc1
    v_mfma_f32_16x16x32_bf16 v[52:55], v[80:83], v[116:119], v[52:55]
    ds_read_b128 v[104:107], v16 offset:15360
    v_mfma_f32_16x16x32_bf16 v[56:59], v[80:83], v[120:123], v[56:59]
    s_waitcnt lgkmcnt(4)
    v_mfma_f32_16x16x32_bf16 v[60:63], v[116:119], v[84:87], v[60:63]
    ds_read_b128 v[76:79], v16 offset:16384
    v_mfma_f32_16x16x32_bf16 v[64:67], v[120:123], v[84:87], v[64:67]
    v_mfma_f32_16x16x32_bf16 v[68:71], v[116:119], v[88:91], v[68:71]
    ds_read_b128 v[80:83], v16 offset:17408
    v_mfma_f32_16x16x32_bf16 v[72:75], v[120:123], v[88:91], v[72:75]
    buffer_load_dwordx4 v[168:171], v15, s[4:7], s22 offen offset:2304 sc1
    s_add_u32 s22, s22, 4096
    s_waitcnt lgkmcnt(4)
    s_waitcnt vmcnt(10)
    v_mfma_f32_16x16x32_bf16 v[28:31], v[92:95], v[124:127], v[28:31]
    ds_read_b128 v[84:87], v16 offset:18432
    v_mfma_f32_16x16x32_bf16 v[32:35], v[92:95], v[128:131], v[32:35]
    v_mfma_f32_16x16x32_bf16 v[36:39], v[96:99], v[124:127], v[36:39]
    ds_read_b128 v[88:91], v16 offset:19456
    v_mfma_f32_16x16x32_bf16 v[40:43], v[96:99], v[128:131], v[40:43]
    s_waitcnt lgkmcnt(4)
    v_mfma_f32_16x16x32_bf16 v[44:47], v[100:103], v[124:127], v[44:47]
    ds_read_b128 v[92:95], v16 offset:20480
    v_mfma_f32_16x16x32_bf16 v[48:51], v[100:103], v[128:131], v[48:51]
    buffer_load_dwordx4 v[172:175], v15, s[4:7], s22 offen offset:0 sc1
    v_mfma_f32_16x16x32_bf16 v[52:55], v[104:107], v[124:127], v[52:55]
    ds_read_b128 v[96:99], v16 offset:21504
    v_mfma_f32_16x16x32_bf16 v[56:59], v[104:107], v[128:131], v[56:59]
    s_waitcnt lgkmcnt(4)
    v_mfma_f32_16x16x32_bf16 v[60:63], v[124:127], v[76:79], v[60:63]
    ds_read_b128 v[100:103], v16 offset:22528
    v_mfma_f32_16x16x32_bf16 v[64:67], v[128:131], v[76:79], v[64:67]
    v_mfma_f32_16x16x32_bf16 v[68:71], v[124:127], v[80:83], v[68:71]
    ds_read_b128 v[104:107], v16 offset:23552
    v_mfma_f32_16x16x32_bf16 v[72:75], v[128:131], v[80:83], v[72:75]
    buffer_load_dwordx4 v[176:179], v15, s[4:7], s22 offen offset:256 sc1
    s_waitcnt lgkmcnt(4)
    s_waitcnt vmcnt(10)
    v_mfma_f32_16x16x32_bf16 v[28:31], v[84:87], v[132:135], v[28:31]
    ds_read_b128 v[76:79], v16 offset:24576
    v_mfma_f32_16x16x32_bf16 v[32:35], v[84:87], v[136:139], v[32:35]
    v_mfma_f32_16x16x32_bf16 v[36:39], v[88:91], v[132:135], v[36:39]
    ds_read_b128 v[80:83], v16 offset:25600
    v_mfma_f32_16x16x32_bf16 v[40:43], v[88:91], v[136:139], v[40:43]
    s_waitcnt lgkmcnt(4)
    v_mfma_f32_16x16x32_bf16 v[44:47], v[92:95], v[132:135], v[44:47]
    ds_read_b128 v[84:87], v16 offset:26624
    v_mfma_f32_16x16x32_bf16 v[48:51], v[92:95], v[136:139], v[48:51]
    buffer_load_dwordx4 v[180:183], v15, s[4:7], s22 offen offset:2048 sc1
    v_mfma_f32_16x16x32_bf16 v[52:55], v[96:99], v[132:135], v[52:55]
    ds_read_b128 v[88:91], v16 offset:27648
    v_mfma_f32_16x16x32_bf16 v[56:59], v[96:99], v[136:139], v[56:59]
    s_waitcnt lgkmcnt(4)
    v_mfma_f32_16x16x32_bf16 v[60:63], v[132:135], v[100:103], v[60:63]
    ds_read_b128 v[92:95], v16 offset:28672
    v_mfma_f32_16x16x32_bf16 v[64:67], v[136:139], v[100:103], v[64:67]
    v_mfma_f32_16x16x32_bf16 v[68:71], v[132:135], v[104:107], v[68:71]
    ds_read_b128 v[96:99], v16 offset:29696
    v_mfma_f32_16x16x32_bf16 v[72:75], v[136:139], v[104:107], v[72:75]
    buffer_load_dwordx4 v[184:187], v15, s[4:7], s22 offen offset:2304 sc1
    s_add_u32 s22, s22, 4096
    s_barrier
    s_waitcnt lgkmcnt(4)
    s_waitcnt vmcnt(10)
    v_mfma_f32_16x16x32_bf16 v[28:31], v[76:79], v[140:143], v[28:31]
    ds_read_b128 v[100:103], v16 offset:30720
    v_mfma_f32_16x16x32_bf16 v[32:35], v[76:79], v[144:147], v[32:35]
    v_mfma_f32_16x16x32_bf16 v[36:39], v[80:83], v[140:143], v[36:39]
    ds_read_b128 v[104:107], v16 offset:31744
    v_mfma_f32_16x16x32_bf16 v[40:43], v[80:83], v[144:147], v[40:43]
    s_waitcnt lgkmcnt(4)
    v_mfma_f32_16x16x32_bf16 v[44:47], v[84:87], v[140:143], v[44:47]
    ds_read_b128 v[76:79], v16 offset:32768
    v_mfma_f32_16x16x32_bf16 v[48:51], v[84:87], v[144:147], v[48:51]
    buffer_load_dwordx4 v[188:191], v15, s[4:7], s22 offen offset:0 sc1
    v_mfma_f32_16x16x32_bf16 v[52:55], v[88:91], v[140:143], v[52:55]
    ds_read_b128 v[80:83], v16 offset:33792
    v_mfma_f32_16x16x32_bf16 v[56:59], v[88:91], v[144:147], v[56:59]
    s_waitcnt lgkmcnt(4)
    v_mfma_f32_16x16x32_bf16 v[60:63], v[140:143], v[92:95], v[60:63]
    ds_read_b128 v[84:87], v16 offset:34816
    v_mfma_f32_16x16x32_bf16 v[64:67], v[144:147], v[92:95], v[64:67]
    v_mfma_f32_16x16x32_bf16 v[68:71], v[140:143], v[96:99], v[68:71]
    ds_read_b128 v[88:91], v16 offset:35840
    v_mfma_f32_16x16x32_bf16 v[72:75], v[144:147], v[96:99], v[72:75]
    buffer_load_dwordx4 v[192:195], v15, s[4:7], s22 offen offset:256 sc1
    s_waitcnt lgkmcnt(4)
    s_waitcnt vmcnt(10)
    v_mfma_f32_16x16x32_bf16 v[28:31], v[100:103], v[148:151], v[28:31]
    ds_read_b128 v[92:95], v16 offset:36864
    v_mfma_f32_16x16x32_bf16 v[32:35], v[100:103], v[152:155], v[32:35]
    v_mfma_f32_16x16x32_bf16 v[36:39], v[104:107], v[148:151], v[36:39]
    ds_read_b128 v[96:99], v16 offset:37888
    v_mfma_f32_16x16x32_bf16 v[40:43], v[104:107], v[152:155], v[40:43]
    s_waitcnt lgkmcnt(4)
    v_mfma_f32_16x16x32_bf16 v[44:47], v[76:79], v[148:151], v[44:47]
    ds_read_b128 v[100:103], v16 offset:38912
    v_mfma_f32_16x16x32_bf16 v[48:51], v[76:79], v[152:155], v[48:51]
    buffer_load_dwordx4 v[196:199], v15, s[4:7], s22 offen offset:2048 sc1
    v_mfma_f32_16x16x32_bf16 v[52:55], v[80:83], v[148:151], v[52:55]
    ds_read_b128 v[104:107], v16 offset:39936
    v_mfma_f32_16x16x32_bf16 v[56:59], v[80:83], v[152:155], v[56:59]
    s_waitcnt lgkmcnt(4)
    v_mfma_f32_16x16x32_bf16 v[60:63], v[148:151], v[84:87], v[60:63]
    ds_read_b128 v[76:79], v16 offset:40960
    v_mfma_f32_16x16x32_bf16 v[64:67], v[152:155], v[84:87], v[64:67]
    v_mfma_f32_16x16x32_bf16 v[68:71], v[148:151], v[88:91], v[68:71]
    ds_read_b128 v[80:83], v16 offset:41984
    v_mfma_f32_16x16x32_bf16 v[72:75], v[152:155], v[88:91], v[72:75]
    buffer_load_dwordx4 v[200:203], v15, s[4:7], s22 offen offset:2304 sc1
    s_add_u32 s22, s22, 4096
    s_waitcnt lgkmcnt(4)
    s_waitcnt vmcnt(10)
    v_mfma_f32_16x16x32_bf16 v[28:31], v[92:95], v[156:159], v[28:31]
    ds_read_b128 v[84:87], v16 offset:43008
    v_mfma_f32_16x16x32_bf16 v[32:35], v[92:95], v[160:163], v[32:35]
    v_mfma_f32_16x16x32_bf16 v[36:39], v[96:99], v[156:159], v[36:39]
    ds_read_b128 v[88:91], v16 offset:44032
    v_mfma_f32_16x16x32_bf16 v[40:43], v[96:99], v[160:163], v[40:43]
    s_waitcnt lgkmcnt(4)
    v_mfma_f32_16x16x32_bf16 v[44:47], v[100:103], v[156:159], v[44:47]
    ds_read_b128 v[92:95], v16 offset:45056
    v_mfma_f32_16x16x32_bf16 v[48:51], v[100:103], v[160:163], v[48:51]
    buffer_load_dwordx4 v[108:111], v15, s[4:7], s22 offen offset:0 sc1
    v_mfma_f32_16x16x32_bf16 v[52:55], v[104:107], v[156:159], v[52:55]
    ds_read_b128 v[96:99], v16 offset:46080
    v_mfma_f32_16x16x32_bf16 v[56:59], v[104:107], v[160:163], v[56:59]
    s_waitcnt lgkmcnt(4)
    v_mfma_f32_16x16x32_bf16 v[60:63], v[156:159], v[76:79], v[60:63]
    ds_read_b128 v[100:103], v16 offset:47104
    v_mfma_f32_16x16x32_bf16 v[64:67], v[160:163], v[76:79], v[64:67]
    v_mfma_f32_16x16x32_bf16 v[68:71], v[156:159], v[80:83], v[68:71]
    ds_read_b128 v[104:107], v16 offset:48128
    v_mfma_f32_16x16x32_bf16 v[72:75], v[160:163], v[80:83], v[72:75]
    buffer_load_dwordx4 v[112:115], v15, s[4:7], s22 offen offset:256 sc1
    s_waitcnt lgkmcnt(4)
    s_waitcnt vmcnt(10)
    v_mfma_f32_16x16x32_bf16 v[28:31], v[84:87], v[164:167], v[28:31]
    ds_read_b128 v[76:79], v16 offset:49152
    v_mfma_f32_16x16x32_bf16 v[32:35], v[84:87], v[168:171], v[32:35]
    v_mfma_f32_16x16x32_bf16 v[36:39], v[88:91], v[164:167], v[36:39]
    ds_read_b128 v[80:83], v16 offset:50176
    v_mfma_f32_16x16x32_bf16 v[40:43], v[88:91], v[168:171], v[40:43]
    s_waitcnt lgkmcnt(4)
    v_mfma_f32_16x16x32_bf16 v[44:47], v[92:95], v[164:167], v[44:47]
    ds_read_b128 v[84:87], v16 offset:51200
    v_mfma_f32_16x16x32_bf16 v[48:51], v[92:95], v[168:171], v[48:51]
    buffer_load_dwordx4 v[116:119], v15, s[4:7], s22 offen offset:2048 sc1
    v_mfma_f32_16x16x32_bf16 v[52:55], v[96:99], v[164:167], v[52:55]
    ds_read_b128 v[88:91], v16 offset:52224
    v_mfma_f32_16x16x32_bf16 v[56:59], v[96:99], v[168:171], v[56:59]
    s_waitcnt lgkmcnt(4)
    v_mfma_f32_16x16x32_bf16 v[60:63], v[164:167], v[100:103], v[60:63]
    ds_read_b128 v[92:95], v16 offset:53248
    v_mfma_f32_16x16x32_bf16 v[64:67], v[168:171], v[100:103], v[64:67]
    v_mfma_f32_16x16x32_bf16 v[68:71], v[164:167], v[104:107], v[68:71]
    ds_read_b128 v[96:99], v16 offset:54272
    v_mfma_f32_16x16x32_bf16 v[72:75], v[168:171], v[104:107], v[72:75]
    buffer_load_dwordx4 v[120:123], v15, s[4:7], s22 offen offset:2304 sc1
    s_add_u32 s22, s22, 4096
    s_barrier
    s_waitcnt lgkmcnt(4)
    s_waitcnt vmcnt(10)
    v_mfma_f32_16x16x32_bf16 v[28:31], v[76:79], v[172:175], v[28:31]
    ds_read_b128 v[100:103], v16 offset:55296
    v_mfma_f32_16x16x32_bf16 v[32:35], v[76:79], v[176:179], v[32:35]
    ds_read_b64 v[22:23], v18 offset:0
    v_mfma_f32_16x16x32_bf16 v[36:39], v[80:83], v[172:175], v[36:39]
    ds_read_b128 v[104:107], v16 offset:56320
    v_mfma_f32_16x16x32_bf16 v[40:43], v[80:83], v[176:179], v[40:43]
    ds_read_b32 v20, v18 offset:8
    s_waitcnt lgkmcnt(6)
    v_mfma_f32_16x16x32_bf16 v[44:47], v[84:87], v[172:175], v[44:47]
    ds_read_b128 v[76:79], v16 offset:57344
    v_mfma_f32_16x16x32_bf16 v[48:51], v[84:87], v[176:179], v[48:51]
    buffer_load_dwordx4 v[124:127], v15, s[4:7], s22 offen offset:0 sc1
    ds_read_b32 v204, v18 offset:12
    v_mfma_f32_16x16x32_bf16 v[52:55], v[88:91], v[172:175], v[52:55]
    ds_read_b128 v[80:83], v16 offset:58368
    v_mfma_f32_16x16x32_bf16 v[56:59], v[88:91], v[176:179], v[56:59]
    ds_read_b128 v[212:215], v19 offset:1024
    s_waitcnt lgkmcnt(8)
    v_mfma_f32_16x16x32_bf16 v[60:63], v[172:175], v[92:95], v[60:63]
    ds_read_b128 v[84:87], v16 offset:59392
    v_mfma_f32_16x16x32_bf16 v[64:67], v[176:179], v[92:95], v[64:67]
    ds_read_b64 v[24:25], v18 offset:512
    v_mfma_f32_16x16x32_bf16 v[68:71], v[172:175], v[96:99], v[68:71]
    ds_read_b128 v[88:91], v16 offset:60416
    v_mfma_f32_16x16x32_bf16 v[72:75], v[176:179], v[96:99], v[72:75]
    buffer_load_dwordx4 v[128:131], v15, s[4:7], s22 offen offset:256 sc1
    ds_read_b32 v21, v18 offset:520
    s_waitcnt lgkmcnt(9)
    s_waitcnt vmcnt(10)
    v_mfma_f32_16x16x32_bf16 v[28:31], v[100:103], v[180:183], v[28:31]
    ds_read_b128 v[92:95], v16 offset:61440
    v_mfma_f32_16x16x32_bf16 v[32:35], v[100:103], v[184:187], v[32:35]
    ds_read_b32 v205, v18 offset:524
    v_mfma_f32_16x16x32_bf16 v[36:39], v[104:107], v[180:183], v[36:39]
    ds_read_b128 v[96:99], v16 offset:62464
    v_mfma_f32_16x16x32_bf16 v[40:43], v[104:107], v[184:187], v[40:43]
    ds_read_b128 v[216:219], v19 offset:1152
    s_waitcnt lgkmcnt(9)
    v_mfma_f32_16x16x32_bf16 v[44:47], v[76:79], v[180:183], v[44:47]
    ds_read_b128 v[100:103], v16 offset:63488
    v_mfma_f32_16x16x32_bf16 v[48:51], v[76:79], v[184:187], v[48:51]
    buffer_load_dwordx4 v[132:135], v15, s[4:7], s22 offen offset:2048 sc1
    v_mfma_f32_16x16x32_bf16 v[52:55], v[80:83], v[180:183], v[52:55]
    ds_read_b128 v[104:107], v16 offset:64512
    v_mfma_f32_16x16x32_bf16 v[56:59], v[80:83], v[184:187], v[56:59]
    s_waitcnt lgkmcnt(7)
    v_mfma_f32_16x16x32_bf16 v[60:63], v[180:183], v[84:87], v[60:63]
    ds_read_b128 v[76:79], v17 offset:0
    v_mfma_f32_16x16x32_bf16 v[64:67], v[184:187], v[84:87], v[64:67]
    v_mfma_f32_16x16x32_bf16 v[68:71], v[180:183], v[88:91], v[68:71]
    ds_read_b128 v[80:83], v17 offset:1024
    v_mfma_f32_16x16x32_bf16 v[72:75], v[184:187], v[88:91], v[72:75]
    buffer_load_dwordx4 v[136:139], v15, s[4:7], s22 offen offset:2304 sc1
    s_add_u32 s22, s22, 4096
    s_waitcnt lgkmcnt(5)
    s_waitcnt vmcnt(10)
    v_mfma_f32_16x16x32_bf16 v[28:31], v[92:95], v[188:191], v[28:31]
    ds_read_b128 v[84:87], v17 offset:6144
    v_mfma_f32_16x16x32_bf16 v[32:35], v[92:95], v[192:195], v[32:35]
    v_mfma_f32_16x16x32_bf16 v[36:39], v[96:99], v[188:191], v[36:39]
    ds_read_b128 v[88:91], v17 offset:7168
    v_mfma_f32_16x16x32_bf16 v[40:43], v[96:99], v[192:195], v[40:43]
    s_waitcnt lgkmcnt(4)
    v_mfma_f32_16x16x32_bf16 v[44:47], v[100:103], v[188:191], v[44:47]
    ds_read_b128 v[92:95], v17 offset:12288
    v_mfma_f32_16x16x32_bf16 v[48:51], v[100:103], v[192:195], v[48:51]
    v_mfma_f32_16x16x32_bf16 v[52:55], v[104:107], v[188:191], v[52:55]
    ds_read_b128 v[96:99], v17 offset:13312
    v_mfma_f32_16x16x32_bf16 v[56:59], v[104:107], v[192:195], v[56:59]
    s_waitcnt lgkmcnt(4)
    v_mfma_f32_16x16x32_bf16 v[60:63], v[188:191], v[76:79], v[60:63]
    ds_read_b128 v[100:103], v17 offset:18432
    v_mfma_f32_16x16x32_bf16 v[64:67], v[192:195], v[76:79], v[64:67]
    v_mfma_f32_16x16x32_bf16 v[68:71], v[188:191], v[80:83], v[68:71]
    ds_read_b128 v[104:107], v17 offset:19456
    v_mfma_f32_16x16x32_bf16 v[72:75], v[192:195], v[80:83], v[72:75]
    s_waitcnt lgkmcnt(4)
    s_waitcnt vmcnt(8)
    v_mfma_f32_16x16x32_bf16 v[60:63], v[196:199], v[84:87], v[60:63]
    ds_read_b128 v[76:79], v17 offset:24576
    v_mfma_f32_16x16x32_bf16 v[64:67], v[200:203], v[84:87], v[64:67]
    v_mfma_f32_16x16x32_bf16 v[68:71], v[196:199], v[88:91], v[68:71]
    ds_read_b128 v[80:83], v17 offset:25600
    v_mfma_f32_16x16x32_bf16 v[72:75], v[200:203], v[88:91], v[72:75]
    s_waitcnt lgkmcnt(4)
    s_waitcnt vmcnt(6)
    v_mfma_f32_16x16x32_bf16 v[60:63], v[108:111], v[92:95], v[60:63]
    ds_read_b128 v[84:87], v17 offset:30720
    v_mfma_f32_16x16x32_bf16 v[64:67], v[112:115], v[92:95], v[64:67]
    v_mfma_f32_16x16x32_bf16 v[68:71], v[108:111], v[96:99], v[68:71]
    ds_read_b128 v[88:91], v17 offset:31744
    v_mfma_f32_16x16x32_bf16 v[72:75], v[112:115], v[96:99], v[72:75]
    s_waitcnt lgkmcnt(4)
    s_waitcnt vmcnt(4)
    v_mfma_f32_16x16x32_bf16 v[60:63], v[116:119], v[100:103], v[60:63]
    ds_read_b128 v[92:95], v17 offset:36864
    v_mfma_f32_16x16x32_bf16 v[64:67], v[120:123], v[100:103], v[64:67]
    v_mfma_f32_16x16x32_bf16 v[68:71], v[116:119], v[104:107], v[68:71]
    ds_read_b128 v[96:99], v17 offset:37888
    v_mfma_f32_16x16x32_bf16 v[72:75], v[120:123], v[104:107], v[72:75]
    s_waitcnt lgkmcnt(4)
    s_waitcnt vmcnt(2)
    v_mfma_f32_16x16x32_bf16 v[60:63], v[124:127], v[76:79], v[60:63]
    ds_read_b128 v[100:103], v17 offset:4096
    v_mfma_f32_16x16x32_bf16 v[64:67], v[128:131], v[76:79], v[64:67]
    v_mfma_f32_16x16x32_bf16 v[68:71], v[124:127], v[80:83], v[68:71]
    ds_read_b128 v[104:107], v17 offset:5120
    v_mfma_f32_16x16x32_bf16 v[72:75], v[128:131], v[80:83], v[72:75]
    s_waitcnt lgkmcnt(4)
    s_waitcnt vmcnt(0)
    v_mfma_f32_16x16x32_bf16 v[60:63], v[132:135], v[84:87], v[60:63]
    ds_read_b128 v[76:79], v17 offset:10240
    v_mfma_f32_16x16x32_bf16 v[64:67], v[136:139], v[84:87], v[64:67]
    v_mfma_f32_16x16x32_bf16 v[68:71], v[132:135], v[88:91], v[68:71]
    ds_read_b128 v[80:83], v17 offset:11264
    v_mfma_f32_16x16x32_bf16 v[72:75], v[136:139], v[88:91], v[72:75]
    s_waitcnt lgkmcnt(4)
    v_mfma_f32_16x16x32_bf16 v[60:63], v[22:25], v[92:95], v[60:63]
    ds_read_b128 v[84:87], v17 offset:16384
    v_mfma_f32_16x16x32_bf16 v[64:67], v[24:27], v[92:95], v[64:67]
    v_mfma_f32_16x16x32_bf16 v[68:71], v[22:25], v[96:99], v[68:71]
    ds_read_b128 v[88:91], v17 offset:17408
    v_mfma_f32_16x16x32_bf16 v[72:75], v[24:27], v[96:99], v[72:75]
    s_waitcnt lgkmcnt(4)
    v_mfma_f32_16x16x32_bf16 v[44:47], v[100:103], v[196:199], v[44:47]
    ds_read_b128 v[92:95], v17 offset:22528
    v_mfma_f32_16x16x32_bf16 v[48:51], v[100:103], v[200:203], v[48:51]
    v_mfma_f32_16x16x32_bf16 v[52:55], v[104:107], v[196:199], v[52:55]
    ds_read_b128 v[96:99], v17 offset:23552
    v_mfma_f32_16x16x32_bf16 v[56:59], v[104:107], v[200:203], v[56:59]
    s_waitcnt lgkmcnt(4)
    v_mfma_f32_16x16x32_bf16 v[44:47], v[76:79], v[108:111], v[44:47]
    ds_read_b128 v[100:103], v17 offset:28672
    v_mfma_f32_16x16x32_bf16 v[48:51], v[76:79], v[112:115], v[48:51]
    s_add_u32 s27, s26, 0x400000
    v_pk_mul_f32 v[60:61], v[212:213], v[60:61]
    v_pk_mul_f32 v[62:63], v[214:215], v[62:63]
    v_pk_mul_f32 v[64:65], v[216:217], v[64:65]
    v_pk_mul_f32 v[66:67], v[218:219], v[66:67]
    v_cvt_pk_bf16_f32 v236, v60, v61
    v_cvt_pk_bf16_f32 v237, v62, v63
    v_cvt_pk_bf16_f32 v238, v64, v65
    v_cvt_pk_bf16_f32 v239, v66, v67
    buffer_store_dwordx4 v[236:239], v2, s[4:7], s27 offen sc1
    s_add_u32 s27, s26, 0x410000
    v_pk_mul_f32 v[68:69], v[212:213], v[68:69]
    v_pk_mul_f32 v[70:71], v[214:215], v[70:71]
    v_pk_mul_f32 v[72:73], v[216:217], v[72:73]
    v_pk_mul_f32 v[74:75], v[218:219], v[74:75]
    v_cvt_pk_bf16_f32 v240, v68, v69
    v_cvt_pk_bf16_f32 v241, v70, v71
    v_cvt_pk_bf16_f32 v242, v72, v73
    v_cvt_pk_bf16_f32 v243, v74, v75
    buffer_store_dwordx4 v[240:243], v2, s[4:7], s27 offen sc1
    v_mfma_f32_16x16x32_bf16 v[52:55], v[80:83], v[108:111], v[52:55]
    ds_read_b128 v[104:107], v17 offset:29696
    v_mfma_f32_16x16x32_bf16 v[56:59], v[80:83], v[112:115], v[56:59]
    s_waitcnt lgkmcnt(4)
    v_mfma_f32_16x16x32_bf16 v[44:47], v[84:87], v[116:119], v[44:47]
    ds_read_b128 v[76:79], v17 offset:34816
    v_mfma_f32_16x16x32_bf16 v[48:51], v[84:87], v[120:123], v[48:51]
    v_mfma_f32_16x16x32_bf16 v[52:55], v[88:91], v[116:119], v[52:55]
    ds_read_b128 v[80:83], v17 offset:35840
    v_mfma_f32_16x16x32_bf16 v[56:59], v[88:91], v[120:123], v[56:59]
    s_waitcnt lgkmcnt(4)
    v_mfma_f32_16x16x32_bf16 v[44:47], v[92:95], v[124:127], v[44:47]
    ds_read_b128 v[84:87], v17 offset:2048
    v_mfma_f32_16x16x32_bf16 v[48:51], v[92:95], v[128:131], v[48:51]
    v_mfma_f32_16x16x32_bf16 v[52:55], v[96:99], v[124:127], v[52:55]
    ds_read_b128 v[88:91], v17 offset:3072
    v_mfma_f32_16x16x32_bf16 v[56:59], v[96:99], v[128:131], v[56:59]
    s_waitcnt lgkmcnt(4)
    v_mfma_f32_16x16x32_bf16 v[44:47], v[100:103], v[132:135], v[44:47]
    ds_read_b128 v[92:95], v17 offset:8192
    v_mfma_f32_16x16x32_bf16 v[48:51], v[100:103], v[136:139], v[48:51]
    v_mfma_f32_16x16x32_bf16 v[52:55], v[104:107], v[132:135], v[52:55]
    ds_read_b128 v[96:99], v17 offset:9216
    v_mfma_f32_16x16x32_bf16 v[56:59], v[104:107], v[136:139], v[56:59]
    s_waitcnt lgkmcnt(4)
    v_mfma_f32_16x16x32_bf16 v[44:47], v[76:79], v[22:25], v[44:47]
    ds_read_b128 v[100:103], v17 offset:14336
    v_mfma_f32_16x16x32_bf16 v[48:51], v[76:79], v[24:27], v[48:51]
    v_mfma_f32_16x16x32_bf16 v[52:55], v[80:83], v[22:25], v[52:55]
    ds_read_b128 v[104:107], v17 offset:15360
    v_mfma_f32_16x16x32_bf16 v[56:59], v[80:83], v[24:27], v[56:59]
    s_waitcnt lgkmcnt(4)
    v_mfma_f32_16x16x32_bf16 v[28:31], v[84:87], v[196:199], v[28:31]
    ds_read_b128 v[76:79], v17 offset:20480
    v_mfma_f32_16x16x32_bf16 v[32:35], v[84:87], v[200:203], v[32:35]
    v_mfma_f32_16x16x32_bf16 v[36:39], v[88:91], v[196:199], v[36:39]
    ds_read_b128 v[80:83], v17 offset:21504
    v_mfma_f32_16x16x32_bf16 v[40:43], v[88:91], v[200:203], v[40:43]
    s_waitcnt lgkmcnt(4)
    v_mfma_f32_16x16x32_bf16 v[28:31], v[92:95], v[108:111], v[28:31]
    ds_read_b128 v[84:87], v17 offset:26624
    v_mfma_f32_16x16x32_bf16 v[32:35], v[92:95], v[112:115], v[32:35]
    s_add_u32 s27, s26, 0x200000
    v_pk_mul_f32 v[44:45], v[44:45], v[20:21] op_sel:[0,0] op_sel_hi:[1,0]
    v_pk_mul_f32 v[46:47], v[46:47], v[20:21] op_sel:[0,0] op_sel_hi:[1,0]
    v_pk_mul_f32 v[52:53], v[52:53], v[20:21] op_sel:[0,0] op_sel_hi:[1,0]
    v_pk_mul_f32 v[54:55], v[54:55], v[20:21] op_sel:[0,0] op_sel_hi:[1,0]
    v_cvt_pk_bf16_f32 v228, v44, v45
    v_cvt_pk_bf16_f32 v229, v46, v47
    v_cvt_pk_bf16_f32 v230, v52, v53
    v_cvt_pk_bf16_f32 v231, v54, v55
    buffer_store_dwordx4 v[228:231], v206, s[4:7], s27 offen offset:0 sc1
    v_pk_mul_f32 v[48:49], v[48:49], v[20:21] op_sel:[0,1] op_sel_hi:[1,1]
    v_pk_mul_f32 v[50:51], v[50:51], v[20:21] op_sel:[0,1] op_sel_hi:[1,1]
    v_pk_mul_f32 v[56:57], v[56:57], v[20:21] op_sel:[0,1] op_sel_hi:[1,1]
    v_pk_mul_f32 v[58:59], v[58:59], v[20:21] op_sel:[0,1] op_sel_hi:[1,1]
    v_cvt_pk_bf16_f32 v232, v48, v49
    v_cvt_pk_bf16_f32 v233, v50, v51
    v_cvt_pk_bf16_f32 v234, v56, v57
    v_cvt_pk_bf16_f32 v235, v58, v59
    buffer_store_dwordx4 v[232:235], v206, s[4:7], s27 offen offset:256 sc1
    v_mfma_f32_16x16x32_bf16 v[36:39], v[96:99], v[108:111], v[36:39]
    ds_read_b128 v[88:91], v17 offset:27648
    v_mfma_f32_16x16x32_bf16 v[40:43], v[96:99], v[112:115], v[40:43]
    s_waitcnt lgkmcnt(4)
    v_mfma_f32_16x16x32_bf16 v[28:31], v[100:103], v[116:119], v[28:31]
    ds_read_b128 v[92:95], v17 offset:32768
    v_mfma_f32_16x16x32_bf16 v[32:35], v[100:103], v[120:123], v[32:35]
    v_mfma_f32_16x16x32_bf16 v[36:39], v[104:107], v[116:119], v[36:39]
    ds_read_b128 v[96:99], v17 offset:33792
    v_mfma_f32_16x16x32_bf16 v[40:43], v[104:107], v[120:123], v[40:43]
    s_waitcnt lgkmcnt(4)
    v_mfma_f32_16x16x32_bf16 v[28:31], v[76:79], v[124:127], v[28:31]
    v_mfma_f32_16x16x32_bf16 v[32:35], v[76:79], v[128:131], v[32:35]
    v_mfma_f32_16x16x32_bf16 v[36:39], v[80:83], v[124:127], v[36:39]
    v_mfma_f32_16x16x32_bf16 v[40:43], v[80:83], v[128:131], v[40:43]
    s_waitcnt lgkmcnt(2)
    v_mfma_f32_16x16x32_bf16 v[28:31], v[84:87], v[132:135], v[28:31]
    v_mfma_f32_16x16x32_bf16 v[32:35], v[84:87], v[136:139], v[32:35]
    v_mfma_f32_16x16x32_bf16 v[36:39], v[88:91], v[132:135], v[36:39]
    v_mfma_f32_16x16x32_bf16 v[40:43], v[88:91], v[136:139], v[40:43]
    s_waitcnt lgkmcnt(0)
    v_mfma_f32_16x16x32_bf16 v[28:31], v[92:95], v[22:25], v[28:31]
    v_mfma_f32_16x16x32_bf16 v[32:35], v[92:95], v[24:27], v[32:35]
    v_mfma_f32_16x16x32_bf16 v[36:39], v[96:99], v[22:25], v[36:39]
    v_mfma_f32_16x16x32_bf16 v[40:43], v[96:99], v[24:27], v[40:43]
    s_nop 7
    s_add_u32 s27, s26, 0x0
    v_pk_mul_f32 v[28:29], v[28:29], v[204:205] op_sel:[0,0] op_sel_hi:[1,0]
    v_pk_mul_f32 v[30:31], v[30:31], v[204:205] op_sel:[0,0] op_sel_hi:[1,0]
    v_pk_mul_f32 v[36:37], v[36:37], v[204:205] op_sel:[0,0] op_sel_hi:[1,0]
    v_pk_mul_f32 v[38:39], v[38:39], v[204:205] op_sel:[0,0] op_sel_hi:[1,0]
    v_cvt_pk_bf16_f32 v220, v28, v29
    v_cvt_pk_bf16_f32 v221, v30, v31
    v_cvt_pk_bf16_f32 v222, v36, v37
    v_cvt_pk_bf16_f32 v223, v38, v39
    buffer_store_dwordx4 v[220:223], v206, s[4:7], s27 offen offset:0 sc1
    v_pk_mul_f32 v[32:33], v[32:33], v[204:205] op_sel:[0,1] op_sel_hi:[1,1]
    v_pk_mul_f32 v[34:35], v[34:35], v[204:205] op_sel:[0,1] op_sel_hi:[1,1]
    v_pk_mul_f32 v[40:41], v[40:41], v[204:205] op_sel:[0,1] op_sel_hi:[1,1]
    v_pk_mul_f32 v[42:43], v[42:43], v[204:205] op_sel:[0,1] op_sel_hi:[1,1]
    v_cvt_pk_bf16_f32 v224, v32, v33
    v_cvt_pk_bf16_f32 v225, v34, v35
    v_cvt_pk_bf16_f32 v226, v40, v41
    v_cvt_pk_bf16_f32 v227, v42, v43
    buffer_store_dwordx4 v[224:227], v206, s[4:7], s27 offen offset:256 sc1
L_qkv_end_69:
    s_branch L_att_2
L_fin_3:
L_done_1:
    s_endpgm
.section .rodata,"a"
.p2align 6
.amdhsa_kernel interleave_layers__mha_block__glu_gated_bilinear__prompt_kernel
  .amdhsa_next_free_vgpr 256
  .amdhsa_next_free_sgpr 102
  .amdhsa_accum_offset 256
  .amdhsa_group_segment_fixed_size 0
  .amdhsa_kernarg_size 80
  .amdhsa_user_sgpr_count 2
  .amdhsa_user_sgpr_kernarg_segment_ptr 1
  .amdhsa_system_sgpr_workgroup_id_x 1
.end_amdhsa_kernel
```
